```python
import torch

def _softmax(x, axis=-1):
    return torch.softmax(x, dim=axis)

def _gelu(x):
    return torch.nn.functional.gelu(x, approximate='tanh')

def _silu(x):
    return torch.nn.functional.silu(x)

def _sigmoid(x):
    return torch.sigmoid(x)

def _layernorm(x, axis=-1, eps=1e-05):
    m = x.mean(dim=axis, keepdim=True)
    v = x.var(dim=axis, keepdim=True, unbiased=False)
    return (x - m) / torch.sqrt(v + eps)

def _scatter_add(tgt, idx, src, axis=0):
    return tgt.clone().index_add_(axis, idx, src)

def _segment_sum(src, seg, n):
    out = torch.zeros((n,) + src.shape[1:], dtype=src.dtype)
    return out.index_add_(0, seg, src)

def _pad(x, pw):
    flat = tuple((v for pair in reversed(pw) for v in pair))
    return torch.nn.functional.pad(x, flat)
kernel_name = 'adaLN_cond__sliding_local_dilated__mixer_channel_mlp__prompt'

def setup_inputs():

    _w = lambda a: (lambda t: t.to(torch.bfloat16) if t.is_floating_point() else t)(torch.as_tensor(a))

    def _A_setup():
        B, S, D = (1, 2048, 512)
        return {'x': _w((lambda *s: torch.randn(*s, dtype=torch.bfloat16) * 0.05)(B, S, D)), 'wqkv': _w((lambda *s: torch.randn(*s, dtype=torch.bfloat16) * 0.05)(D, 3 * D)), 'wo': _w((lambda *s: torch.randn(*s, dtype=torch.bfloat16) * 0.05)(D, D))}
    _A_in = _A_setup()

    def _B_setup():
        B, S, D, F = (1, 2048, 512, 1792)
        return {'x': _w((lambda *s: torch.randn(*s, dtype=torch.bfloat16) * 0.05)(B, S, D)), 'w1': _w((lambda *s: torch.randn(*s, dtype=torch.bfloat16) * 3.2)(D, F) * D ** (-0.5)), 'b1': _w((lambda *s: torch.randn(*s, dtype=torch.bfloat16) * 1.6)(F)), 'w2': _w((lambda *s: torch.randn(*s, dtype=torch.bfloat16) * 3.2)(F, D) * F ** (-0.5)), 'b2': _w((lambda *s: torch.randn(*s, dtype=torch.bfloat16) * 3.2)(D))}
    _B_in = _B_setup()
    return {'A_x': _A_in['x'], 'A_wqkv': _A_in['wqkv'], 'A_wo': _A_in['wo'], 'B_x': _B_in['x'], 'B_w1': _B_in['w1'], 'B_b1': _B_in['b1'], 'B_w2': _B_in['w2'], 'B_b2': _B_in['b2'], 'c': _w((lambda *s: torch.randn(*s, dtype=torch.bfloat16) * 0.2)(1, 512) * 8.0), 'w_mod': _w((lambda *s: torch.randn(*s, dtype=torch.bfloat16) * 0.2)(512, 6 * 512) * 512 ** (-0.5) * 8.0)}

def reference(A_x, A_wqkv, A_wo, B_x, B_w1, B_b1, B_w2, B_b2, c, w_mod):

    def _A_ref(x, wqkv, wo):
        B, S, D = x.shape
        H = 32
        Dh = D // H
        W, dil = (8, 2)
        qkv = (lambda x, *d: x.permute(*d))((x @ wqkv).reshape(B, S, 3, H, Dh), 2, 0, 3, 1, 4)
        q, k, v = (qkv[0], qkv[1], qkv[2])
        scale = Dh ** (-0.5)
        pos = torch.arange(S)
        off = torch.arange(W) * dil
        idx = pos[:, None] - off[None, :]
        mask = idx >= 0
        idx_c = torch.where(mask, idx, 0).reshape(-1)
        kg = k[:, :, idx_c, :].reshape(B, H, S, W, Dh)
        vg = v[:, :, idx_c, :].reshape(B, H, S, W, Dh)
        logits = torch.einsum('bhsd,bhswd->bhsw', q, kg) * scale
        logits = torch.where(mask[None, None, :, :], logits, -1000000000.0)
        attn = _softmax(logits, axis=-1)
        o = torch.einsum('bhsw,bhswd->bhsd', attn, vg)
        return (lambda x, *d: x.permute(*d))(o, 0, 2, 1, 3).reshape(B, S, D) @ wo

    def _B_ref(x, w1, b1, w2, b2):
        y = _layernorm(x, axis=-1)
        h = _gelu(torch.einsum('bsd,df->bsf', y, w1) + b1)
        return torch.einsum('bsf,fd->bsd', h, w2) + b2
    x = A_x
    mod = (_silu(c) @ w_mod).reshape(c.shape[0], 6, 1, -1)
    sa, ca, ga, sb, cb, gb = (mod[:, 0].clone(), mod[:, 1].clone(), mod[:, 2].clone(), mod[:, 3].clone(), mod[:, 4].clone(), mod[:, 5].clone())
    h = _layernorm(x, axis=-1) * (1 + ca) + sa
    x = x + ga * _A_ref(h, A_wqkv, A_wo)
    h = _layernorm(x, axis=-1) * (1 + cb) + sb
    x = x + gb * _B_ref(h, B_w1, B_b1, B_w2, B_b2)
    return x
```

```asm
; @launch grid=(256,1,1) block=(256,1,1) lds=163840
.amdgcn_target "amdgcn-amd-amdhsa--gfx950"
.text
.globl adaLN_cond__sliding_local_dilated__mixer_channel_mlp__prompt_kernel
.p2align 8
.type adaLN_cond__sliding_local_dilated__mixer_channel_mlp__prompt_kernel,@function
adaLN_cond__sliding_local_dilated__mixer_channel_mlp__prompt_kernel:
    s_cmp_ge_u32 s2, 256
    s_cbranch_scc1 L_end
    s_load_dwordx2 s[40:41], s[0:1], 64
    s_load_dwordx2 s[36:37], s[0:1], 96
    s_load_dwordx2 s[28:29], s[0:1], 72
    s_load_dwordx2 s[8:9], s[0:1], 0
    s_load_dwordx2 s[12:13], s[0:1], 8
    s_load_dwordx2 s[16:17], s[0:1], 16
    s_load_dwordx2 s[20:21], s[0:1], 32
    s_load_dwordx2 s[24:25], s[0:1], 48
    s_load_dwordx2 s[32:33], s[0:1], 80
    s_load_dwordx2 s[42:43], s[0:1], 40
    s_load_dwordx2 s[44:45], s[0:1], 56
    s_load_dwordx2 s[46:47], s[0:1], 88
    s_getpc_b64 s[92:93]
L_pc:
    v_lshrrev_b32 v4, 6, v0
    v_lshlrev_b32 v2, 4, v0
    v_readfirstlane_b32 s5, v4
    v_and_b32 v0, 63, v0
    s_and_b32 s3, s2, 7
    s_lshr_b32 s4, s2, 3
    s_lshl_b32 s94, s4, 2
    s_add_u32 s94, s94, s5
    s_lshl_b32 s94, s94, 9
    v_and_b32 v3, 3, v0
    v_lshl_add_u32 v3, v3, 7, s94
    v_min_u32 v3, L_end-L_pc, v3
    global_load_dword v255, v3, s[92:93]
    v_lshlrev_b32 v1, 4, v0
    s_mov_b32 s10, 2097152
    s_mov_b32 s11, 0x20000
    s_mov_b32 s14, 1572864
    s_mov_b32 s15, 0x20000
    s_mov_b32 s18, 524288
    s_mov_b32 s19, 0x20000
    s_mov_b32 s22, 1835008
    s_mov_b32 s23, 0x20000
    s_mov_b32 s34, 2097152
    s_mov_b32 s35, 0x20000
    s_mov_b32 s38, 268435456
    s_mov_b32 s39, 0x20000
    s_cmp_lt_u32 s4, 8
    s_cselect_b32 s30, 3145728, 0
    s_mov_b32 s31, 0x20000
    s_cmp_lt_u32 s4, 28
    s_cselect_b32 s26, 1835008, 0
    s_mov_b32 s27, 0x20000
    s_lshr_b32 s82, s4, 3
    s_and_b32 s89, s4, 7
    s_lshl_b32 s88, s3, 2
    s_add_u32 s88, s88, s82
    s_lshr_b32 s90, s88, 1
    s_and_b32 s91, s4, 15
    s_mov_b32 s7, 1
    s_and_b32 s94, s3, 1
    s_lshl_b32 s95, s94, 3
    s_lshl_b32 s94, s94, 4
    s_add_u32 s94, s94, 8
    s_cmp_lt_u32 s4, 8
    s_cselect_b32 s94, s95, s94
    s_add_u32 s101, s94, s4
    s_mov_b32 s82, 0
    v_lshrrev_b32 v3, 3, v0
    v_lshlrev_b32 v3, 2, v3
    s_lshr_b32 s95, s3, 1
    s_lshl_b32 s95, s95, 2
    s_add_u32 s95, s95, s5
    s_lshl_b32 s95, s95, 5
    v_add_u32 v3, s95, v3
    v_and_b32 v4, 7, v0
    v_lshlrev_b32 v4, 4, v4
    s_movk_i32 s95, 6144
    v_mad_u32_u24 v15, v3, s95, v4
    v_lshlrev_b32 v5, 1, v3
    v_lshrrev_b32 v9, 4, v0
    v_and_b32 v10, 15, v0
    v_lshlrev_b32 v10, 4, v10
    v_lshl_add_u32 v7, v9, 11, v10
    s_lshl_b32 s94, s88, 16
    s_lshl_b32 s86, s5, 13
    s_add_u32 s86, s94, s86
    s_and_b32 s85, s5, 1
    s_lshl_b32 s85, s85, 3
    s_lshr_b32 s97, s5, 1
    s_add_u32 s85, s85, s97
    s_lshl_b32 s85, s85, 10
    s_add_u32 s85, s85, s94
    s_cmp_eq_u32 s88, 0
    s_cselect_b32 s97, 0, 16384
    s_sub_u32 s85, s85, s97
    s_add_u32 s87, s86, 32768
    s_lshl_b32 s95, s89, 2
    s_add_u32 s95, s95, s5
    s_mul_i32 s95, s95, 2560
    s_add_u32 s95, s95, s94
    s_sub_u32 s95, s95, 16384
    v_min_u32 v6, 19, v0
    v_lshl_add_u32 v6, v6, 7, s95
    s_lshl_b32 s96, s2, 2
    s_add_u32 s96, s96, s5
    s_mul_i32 s95, s96, 1536
    v_min_u32 v8, 11, v0
    v_lshl_add_u32 v8, v8, 7, s95
    s_waitcnt lgkmcnt(0)
    global_load_dwordx2 v[248:249], v5, s[40:41]
    buffer_load_dword v252, off, s[36:39], 0 sc1
    s_lshl_b32 s94, s101, 7
    buffer_load_dwordx4 v[176:179], v15, s[28:31], s94 offen
    s_add_u32 s94, s94, 6144
    buffer_load_dwordx4 v[180:183], v15, s[28:31], s94 offen
    s_add_u32 s94, s94, 6144
    buffer_load_dwordx4 v[184:187], v15, s[28:31], s94 offen
    s_add_u32 s94, s94, 6144
    buffer_load_dwordx4 v[188:191], v15, s[28:31], s94 offen
    buffer_load_dword v255, v6, s[8:11], 0 offen
    buffer_load_dwordx4 v[20:23], v7, s[8:11], s85 offen offset:0
    buffer_load_dwordx4 v[28:31], v7, s[8:11], s85 offen offset:256
    buffer_load_dwordx4 v[36:39], v7, s[8:11], s85 offen offset:512
    buffer_load_dwordx4 v[44:47], v7, s[8:11], s85 offen offset:768
    buffer_load_dwordx4 v[52:55], v7, s[8:11], s86 offen offset:0
    buffer_load_dwordx4 v[60:63], v7, s[8:11], s86 offen offset:256
    s_mov_b32 s0, 0xffff0000
    v_lshrrev_b32 v9, 3, v0
    v_bfe_u32 v10, v0, 4, 1
    v_bfe_u32 v11, v0, 1, 2
    v_xor_b32 v10, v10, v11
    v_and_b32 v11, 1, v0
    v_lshlrev_b32 v11, 4, v11
    s_movk_i32 s94, 3072
    v_mad_u32_u24 v11, v9, s94, v11
    s_mul_i32 s94, s5, 98304
    s_lshl_b32 s95, s89, 7
    s_add_u32 s94, s94, s95
    v_add_u32 v11, s94, v11
    v_lshl_add_u32 v3, v10, 5, v11
    v_xor_b32 v10, 2, v10
    v_lshl_add_u32 v4, v10, 5, v11
    v_add_u32 v4, 23552, v4
    v_add_u32 v5, 47104, v3
    v_add_u32 v6, 47104, v4
    s_lshl_b32 s84, s5, 12
    v_mov_b32 v215, v8
    s_lshr_b32 s94, s12, 7
    s_sub_u32 s94, 3, s94
    s_and_b32 s94, s94, 7
    s_lshl_b32 s94, s94, 7
    s_lshl_b32 s97, s4, 2
    s_add_u32 s97, s97, s5
    s_mul_i32 s97, s97, 12288
    s_add_u32 s94, s94, s97
    v_and_b32 v9, 31, v0
    v_min_u32 v9, 11, v9
    v_lshl_add_u32 v9, v9, 10, s94
    v_cmp_lt_u32 vcc, 31, v0
    s_nop 1
    v_cndmask_b32 v215, v215, v9, vcc
    v_bfe_u32 v9, v0, 2, 2
    v_lshrrev_b32 v10, 4, v0
    v_lshl_add_u32 v11, v10, 3, v9
    v_lshrrev_b32 v9, 1, v9
    v_and_b32 v10, 1, v10
    v_lshl_or_b32 v9, v10, 1, v9
    v_xor_b32 v9, s5, v9
    v_lshlrev_b32 v11, 7, v11
    v_lshl_add_u32 v11, v9, 5, v11
    v_and_b32 v9, 3, v0
    v_lshl_add_u32 v12, v9, 3, v11
    v_add_u32 v13, 49152, v12
    v_add_u32 v14, 98304, v12
    s_lshl_b32 s94, s5, 2
    v_lshrrev_b32 v9, 4, v0
    v_add_u32 v9, s94, v9
    v_and_b32 v10, 15, v0
    v_xor_b32 v10, v10, v9
    v_lshlrev_b32 v10, 4, v10
    v_lshl_add_u32 v10, v9, 10, v10
    s_sub_u32 s94, 0, s82
    s_and_b32 s94, s94, 3
    s_lshl_b32 s94, s94, 8
    s_add_u32 s94, s94, 81920
    v_add_u32 v216, s94, v10
    s_sub_u32 s94, 1, s82
    s_and_b32 s94, s94, 3
    s_lshl_b32 s94, s94, 8
    s_add_u32 s94, s94, 81920
    v_add_u32 v217, s94, v10
    s_sub_u32 s94, 2, s82
    s_and_b32 s94, s94, 3
    s_lshl_b32 s94, s94, 8
    s_add_u32 s94, s94, 81920
    v_add_u32 v218, s94, v10
    s_sub_u32 s94, 3, s82
    s_and_b32 s94, s94, 3
    s_lshl_b32 s94, s94, 8
    s_add_u32 s94, s94, 81920
    v_add_u32 v219, s94, v10
    v_and_b32 v9, 15, v0
    v_lshrrev_b32 v10, 4, v0
    v_lshlrev_b32 v11, 10, v9
    v_add_u32 v11, 65536, v11
    v_add_u32 v220, 0, v10
    v_xor_b32 v220, v220, v9
    v_lshl_add_u32 v220, v220, 4, v11
    v_add_u32 v221, 4, v10
    v_xor_b32 v221, v221, v9
    v_lshl_add_u32 v221, v221, 4, v11
    v_add_u32 v222, 8, v10
    v_xor_b32 v222, v222, v9
    v_lshl_add_u32 v222, v222, 4, v11
    v_add_u32 v223, 12, v10
    v_xor_b32 v223, v223, v9
    v_lshl_add_u32 v223, v223, 4, v11
    v_lshrrev_b32 v9, 3, v0
    v_and_b32 v10, 7, v0
    v_lshlrev_b32 v10, 4, v10
    v_lshl_add_u32 v238, v9, 10, v10
    v_add_u32 v239, 7168, v238
    v_lshrrev_b32 v9, 5, v0
    v_bfe_u32 v10, v0, 2, 2
    v_lshl_add_u32 v9, v9, 3, v10
    v_lshlrev_b32 v9, 7, v9
    v_bfe_u32 v10, v0, 4, 1
    v_lshl_add_u32 v9, v10, 5, v9
    v_and_b32 v10, 3, v0
    v_lshl_add_u32 v9, v10, 3, v9
    s_lshl_b32 s96, s5, 11
    s_add_u32 s96, s96, 147456
    v_add_u32 v8, s96, v9
    v_and_b32 v9, 15, v0
    v_lshrrev_b32 v10, 4, v0
    v_lshlrev_b32 v10, 2, v10
    v_add_u32 v11, 0, v10
    v_sub_u32 v231, v9, v11
    v_cmp_ge_u32 s[48:49], 7, v231
    v_cmp_ge_i32 s[56:57], -9, v231
    v_cmp_gt_i32 s[64:65], 0, v231
    v_cmp_ge_u32 vcc, 7, v11
    s_nop 0
    s_and_b64 s[64:65], s[64:65], vcc
    v_add_u32 v11, 1, v10
    v_sub_u32 v231, v9, v11
    v_cmp_ge_u32 s[50:51], 7, v231
    v_cmp_ge_i32 s[58:59], -9, v231
    v_cmp_gt_i32 s[66:67], 0, v231
    v_cmp_ge_u32 vcc, 7, v11
    s_nop 0
    s_and_b64 s[66:67], s[66:67], vcc
    v_add_u32 v11, 2, v10
    v_sub_u32 v231, v9, v11
    v_cmp_ge_u32 s[52:53], 7, v231
    v_cmp_ge_i32 s[60:61], -9, v231
    v_cmp_gt_i32 s[68:69], 0, v231
    v_cmp_ge_u32 vcc, 7, v11
    s_nop 0
    s_and_b64 s[68:69], s[68:69], vcc
    v_add_u32 v11, 3, v10
    v_sub_u32 v231, v9, v11
    v_cmp_ge_u32 s[54:55], 7, v231
    v_cmp_ge_i32 s[62:63], -9, v231
    v_cmp_gt_i32 s[70:71], 0, v231
    v_cmp_ge_u32 vcc, 7, v11
    s_nop 0
    s_and_b64 s[70:71], s[70:71], vcc
    s_cmp_eq_u32 s88, 0
    s_cselect_b64 s[72:73], 0, s[56:57]
    s_cselect_b64 s[64:65], 0, s[64:65]
    s_cselect_b64 s[74:75], 0, s[58:59]
    s_cselect_b64 s[66:67], 0, s[66:67]
    s_cselect_b64 s[76:77], 0, s[60:61]
    s_cselect_b64 s[68:69], 0, s[68:69]
    s_cselect_b64 s[78:79], 0, s[62:63]
    s_cselect_b64 s[70:71], 0, s[70:71]
    v_and_b32 v9, 15, v0
    v_lshlrev_b32 v9, 4, v9
    v_lshrrev_b32 v10, 5, v0
    v_lshl_add_u32 v9, v10, 8, v9
    v_bfe_u32 v10, v0, 4, 1
    v_lshl_add_u32 v231, v10, 3, v9
    s_lshl_b32 s81, s88, 16
    s_lshl_b32 s95, s89, 11
    s_add_u32 s81, s81, s95
    s_lshl_b32 s95, s5, 9
    s_add_u32 s81, s81, s95
    s_add_u32 s81, s81, 1048576
    s_mov_b32 s80, 0x3eb8aa3b
    v_lshrrev_b32 v9, 3, v0
    v_bfe_u32 v10, v0, 4, 1
    v_lshlrev_b32 v10, 2, v10
    v_and_b32 v11, 7, v0
    v_xor_b32 v10, v10, v11
    v_lshlrev_b32 v9, 10, v9
    v_lshl_add_u32 v232, v10, 4, v9
    v_add_u32 v233, 7160, v232
    v_add_u32 v234, 14320, v232
    v_add_u32 v235, 21480, v232
    v_bfe_u32 v9, v0, 2, 2
    v_lshrrev_b32 v10, 4, v0
    v_mul_u32_u24 v10, 1032, v10
    v_lshl_add_u32 v10, v9, 7, v10
    v_lshrrev_b32 v9, 1, v9
    v_lshlrev_b32 v9, 2, v9
    v_and_b32 v11, 3, v0
    v_or_b32 v9, v9, v11
    v_lshl_add_u32 v236, v9, 4, v10
    v_xor_b32 v9, 4, v9
    v_lshl_add_u32 v237, v9, 4, v10
    s_movk_i32 s94, 4682
    s_movk_i32 s95, 3584
    s_mul_i32 s96, s91, 224
    v_add_u32 v9, 0, v0
    v_mul_u32_u24 v10, s94, v9
    v_lshrrev_b32 v10, 16, v10
    v_mul_u32_u24 v11, 14, v10
    v_sub_u32 v9, v9, v11
    v_and_b32 v11, 19, v10
    v_bfe_u32 v224, v10, 2, 1
    v_lshl_or_b32 v11, v224, 3, v11
    v_bfe_u32 v224, v10, 3, 1
    v_lshl_or_b32 v11, v224, 2, v11
    v_lshlrev_b32 v9, 4, v9
    v_mad_u32_u24 v9, v11, s95, v9
    s_sub_u32 s97, s96, 0
    v_add_u32 v224, s97, v9
    v_add_u32 v9, 64, v0
    v_mul_u32_u24 v10, s94, v9
    v_lshrrev_b32 v10, 16, v10
    v_mul_u32_u24 v11, 14, v10
    v_sub_u32 v9, v9, v11
    v_and_b32 v11, 19, v10
    v_bfe_u32 v225, v10, 2, 1
    v_lshl_or_b32 v11, v225, 3, v11
    v_bfe_u32 v225, v10, 3, 1
    v_lshl_or_b32 v11, v225, 2, v11
    v_lshlrev_b32 v9, 4, v9
    v_mad_u32_u24 v9, v11, s95, v9
    s_sub_u32 s97, s96, 1024
    v_add_u32 v225, s97, v9
    v_add_u32 v9, 128, v0
    v_mul_u32_u24 v10, s94, v9
    v_lshrrev_b32 v10, 16, v10
    v_mul_u32_u24 v11, 14, v10
    buffer_load_dword v255, v215, s[12:15], 0 offen
    v_sub_u32 v9, v9, v11
    v_and_b32 v11, 19, v10
    v_bfe_u32 v226, v10, 2, 1
    v_lshl_or_b32 v11, v226, 3, v11
    v_bfe_u32 v226, v10, 3, 1
    v_lshl_or_b32 v11, v226, 2, v11
    v_lshlrev_b32 v9, 4, v9
    v_mad_u32_u24 v9, v11, s95, v9
    s_sub_u32 s97, s96, 2048
    v_add_u32 v226, s97, v9
    v_add_u32 v9, 192, v0
    v_mul_u32_u24 v10, s94, v9
    v_lshrrev_b32 v10, 16, v10
    v_mul_u32_u24 v11, 14, v10
    v_sub_u32 v9, v9, v11
    v_and_b32 v11, 19, v10
    v_bfe_u32 v227, v10, 2, 1
    v_lshl_or_b32 v11, v227, 3, v11
    v_bfe_u32 v227, v10, 3, 1
    v_lshl_or_b32 v11, v227, 2, v11
    v_lshlrev_b32 v9, 4, v9
    v_mad_u32_u24 v9, v11, s95, v9
    s_sub_u32 s97, s96, 3072
    v_add_u32 v227, s97, v9
    v_add_u32 v9, 256, v0
    v_mul_u32_u24 v10, s94, v9
    v_lshrrev_b32 v10, 16, v10
    v_mul_u32_u24 v11, 14, v10
    v_sub_u32 v9, v9, v11
    v_and_b32 v11, 19, v10
    v_bfe_u32 v228, v10, 2, 1
    v_lshl_or_b32 v11, v228, 3, v11
    v_bfe_u32 v228, v10, 3, 1
    v_lshl_or_b32 v11, v228, 2, v11
    v_lshlrev_b32 v9, 4, v9
    v_mad_u32_u24 v9, v11, s95, v9
    s_sub_u32 s97, s96, 0
    v_add_u32 v228, s97, v9
    v_add_u32 v9, 320, v0
    v_mul_u32_u24 v10, s94, v9
    v_lshrrev_b32 v10, 16, v10
    v_mul_u32_u24 v11, 14, v10
    v_sub_u32 v9, v9, v11
    v_and_b32 v11, 19, v10
    v_bfe_u32 v229, v10, 2, 1
    v_lshl_or_b32 v11, v229, 3, v11
    v_bfe_u32 v229, v10, 3, 1
    v_lshl_or_b32 v11, v229, 2, v11
    v_lshlrev_b32 v9, 4, v9
    v_mad_u32_u24 v9, v11, s95, v9
    s_sub_u32 s97, s96, 1024
    v_add_u32 v229, s97, v9
    v_add_u32 v9, 384, v0
    v_mul_u32_u24 v10, s94, v9
    v_lshrrev_b32 v10, 16, v10
    v_mul_u32_u24 v11, 14, v10
    v_sub_u32 v9, v9, v11
    v_and_b32 v11, 19, v10
    v_bfe_u32 v230, v10, 2, 1
    v_lshl_or_b32 v11, v230, 3, v11
    v_bfe_u32 v230, v10, 3, 1
    v_lshl_or_b32 v11, v230, 2, v11
    v_lshlrev_b32 v9, 4, v9
    v_mad_u32_u24 v9, v11, s95, v9
    s_sub_u32 s97, s96, 2048
    v_add_u32 v230, s97, v9
    v_and_b32 v9, 7, v0
    v_lshlrev_b32 v9, 2, v9
    v_lshrrev_b32 v10, 4, v0
    v_add_u32 v9, v9, v10
    s_lshl_b32 s96, s5, 8
    s_add_u32 s96, s96, 155648
    v_lshl_add_u32 v9, v9, 3, s96
    s_sub_u32 s96, s4, 0
    s_cmp_lt_u32 s96, 8
    s_cselect_b32 s96, 16, 0
    s_cmp_eq_u32 s5, 0
    s_cselect_b32 s96, s96, 0
    v_and_b32 v10, 15, v0
    v_lshlrev_b32 v10, 4, v10
    v_add_u32 v11, 155648, v10
    v_cmp_gt_u32 vcc, s96, v0
    s_nop 1
    v_cndmask_b32_e64 v214, 1, 0, vcc
    v_lshl_or_b32 v10, v214, 28, v10
    s_waitcnt vmcnt(13)
    v_lshlrev_b32 v240, 16, v248
    v_and_b32 v241, s0, v248
    v_lshlrev_b32 v242, 16, v249
    v_and_b32 v243, s0, v249
    s_waitcnt vmcnt(12)
    v_add_u32 v252, 1, v252
    v_mul_f32 v244, 0xbfb8aa3b, v240
    v_mul_f32 v245, 0xbfb8aa3b, v241
    v_mul_f32 v246, 0xbfb8aa3b, v242
    v_mul_f32 v247, 0xbfb8aa3b, v243
    v_readfirstlane_b32 s6, v252
    v_exp_f32 v244, v244
    v_exp_f32 v245, v245
    v_exp_f32 v246, v246
    v_exp_f32 v247, v247
    v_add_f32 v244, 1.0, v244
    v_add_f32 v245, 1.0, v245
    v_add_f32 v246, 1.0, v246
    v_add_f32 v247, 1.0, v247
    v_rcp_f32 v244, v244
    v_rcp_f32 v245, v245
    v_rcp_f32 v246, v246
    v_rcp_f32 v247, v247
    v_mul_f32 v240, v240, v244
    v_mul_f32 v241, v241, v245
    v_mul_f32 v242, v242, v246
    v_mul_f32 v243, v243, v247
    v_cvt_pk_bf16_f32 v250, v240, v241
    v_cvt_pk_bf16_f32 v251, v242, v243
    s_cmp_ge_u32 s4, 8
    s_cbranch_scc1 L_nomod
    s_mov_b32 s96, 0x05040100
    s_mov_b32 s97, 0x07060302
    s_waitcnt vmcnt(10)
    v_perm_b32 v192, v180, v176, s96
    v_perm_b32 v193, v180, v176, s97
    v_perm_b32 v194, v181, v177, s96
    v_perm_b32 v195, v181, v177, s97
    v_perm_b32 v196, v182, v178, s96
    v_perm_b32 v197, v182, v178, s97
    v_perm_b32 v198, v183, v179, s96
    v_perm_b32 v199, v183, v179, s97
    v_dot2_f32_bf16 v208, v192, v250, 0
    v_dot2_f32_bf16 v209, v193, v250, 0
    v_dot2_f32_bf16 v210, v194, v250, 0
    v_dot2_f32_bf16 v211, v195, v250, 0
    v_dot2_f32_bf16 v212, v196, v250, 0
    v_dot2_f32_bf16 v213, v197, v250, 0
    v_dot2_f32_bf16 v214, v198, v250, 0
    v_dot2_f32_bf16 v215, v199, v250, 0
    s_waitcnt vmcnt(8)
    v_perm_b32 v200, v188, v184, s96
    v_perm_b32 v201, v188, v184, s97
    v_perm_b32 v202, v189, v185, s96
    v_perm_b32 v203, v189, v185, s97
    v_perm_b32 v204, v190, v186, s96
    v_perm_b32 v205, v190, v186, s97
    v_perm_b32 v206, v191, v187, s96
    v_perm_b32 v207, v191, v187, s97
    v_dot2_f32_bf16 v208, v200, v251, v208
    v_dot2_f32_bf16 v209, v201, v251, v209
    v_dot2_f32_bf16 v210, v202, v251, v210
    v_dot2_f32_bf16 v211, v203, v251, v211
    v_dot2_f32_bf16 v212, v204, v251, v212
    v_dot2_f32_bf16 v213, v205, v251, v213
    v_dot2_f32_bf16 v214, v206, v251, v214
    v_dot2_f32_bf16 v215, v207, v251, v215
    v_permlane32_swap_b32 v208, v212
    v_permlane32_swap_b32 v209, v213
    v_permlane32_swap_b32 v210, v214
    v_permlane32_swap_b32 v211, v215
    v_add_f32 v208, v208, v212
    v_add_f32 v209, v209, v213
    v_add_f32 v210, v210, v214
    v_add_f32 v211, v211, v215
    s_nop 0
    v_permlane16_swap_b32 v208, v210
    v_permlane16_swap_b32 v209, v211
    v_add_f32 v208, v208, v210
    v_add_f32 v209, v209, v211
    s_nop 0
    v_add_f32_dpp v208, v208, v208 row_ror:8 row_mask:0xf bank_mask:0xf
    v_add_f32_dpp v209, v209, v209 row_ror:8 row_mask:0xf bank_mask:0xf
    ds_write_b64 v9, v[208:209]
    s_waitcnt lgkmcnt(0)
    s_barrier
    ds_read_b128 v[192:195], v11 offset:0
    ds_read_b128 v[196:199], v11 offset:256
    ds_read_b128 v[200:203], v11 offset:512
    ds_read_b128 v[204:207], v11 offset:768
    s_waitcnt lgkmcnt(2)
    v_add_f32 v192, v192, v196
    v_add_f32 v193, v193, v197
    v_add_f32 v194, v194, v198
    v_add_f32 v195, v195, v199
    s_waitcnt lgkmcnt(0)
    v_add_f32 v200, v200, v204
    v_add_f32 v201, v201, v205
    v_add_f32 v202, v202, v206
    v_add_f32 v203, v203, v207
    v_add_f32 v192, v192, v200
    v_add_f32 v193, v193, v201
    v_add_f32 v194, v194, v202
    v_add_f32 v195, v195, v203
    v_add_u32 v192, 0x80, v192
    v_add_u32 v193, 0x80, v193
    v_add_u32 v194, 0x80, v194
    v_add_u32 v195, 0x80, v195
    s_mov_b32 s96, 117835008
    v_perm_b32 v208, v192, v252, s96
    s_mov_b32 s96, 117835009
    v_perm_b32 v209, v193, v252, s96
    s_mov_b32 s96, 117835010
    v_perm_b32 v210, v194, v252, s96
    s_mov_b32 s96, 117835011
    v_perm_b32 v211, v195, v252, s96
L_nomod:
    s_lshr_b32 s96, s3, 1
    s_mul_i32 s96, s96, 12288
    s_lshl_b32 s97, s101, 8
    s_add_u32 s96, s96, s97
    s_add_u32 s96, s96, 589824
    buffer_store_dwordx4 v[208:211], v10, s[36:39], s96 offen sc1
    v_lshrrev_b32 v11, 2, v2
    v_add_u32 v11, 156672, v11
    v_mov_b32 v9, 0x3f803f80
    ds_write_b32 v11, v9
    v_mov_b32 v240, 0
    v_mov_b32 v241, 0
    v_mov_b32 v242, 0
    v_mov_b32 v243, 0
    v_mov_b32 v244, 0
    v_mov_b32 v245, 0
    v_mov_b32 v246, 0
    v_mov_b32 v247, 0
    v_mov_b32 v248, 0
    v_mov_b32 v249, 0
    s_sub_u32 s94, s4, 8
    s_cmp_lt_u32 s94, 16
    s_cselect_b32 s30, 3145728, 0
    buffer_load_dwordx4 v[68:71], v7, s[8:11], s86 offen offset:512
    buffer_load_dwordx4 v[76:79], v7, s[8:11], s86 offen offset:768
    s_waitcnt vmcnt(9)
    v_dot2c_f32_bf16 v241, v20, v9
    v_dot2c_f32_bf16 v240, v20, v20
    v_dot2c_f32_bf16 v241, v21, v9
    v_dot2c_f32_bf16 v240, v21, v21
    v_dot2c_f32_bf16 v241, v22, v9
    v_dot2c_f32_bf16 v240, v22, v22
    v_dot2c_f32_bf16 v241, v23, v9
    v_dot2c_f32_bf16 v240, v23, v23
    s_waitcnt vmcnt(8)
    v_dot2c_f32_bf16 v241, v28, v9
    v_dot2c_f32_bf16 v240, v28, v28
    v_dot2c_f32_bf16 v241, v29, v9
    v_dot2c_f32_bf16 v240, v29, v29
    v_dot2c_f32_bf16 v241, v30, v9
    v_dot2c_f32_bf16 v240, v30, v30
    v_dot2c_f32_bf16 v241, v31, v9
    v_dot2c_f32_bf16 v240, v31, v31
    s_waitcnt vmcnt(7)
    v_dot2c_f32_bf16 v241, v36, v9
    v_dot2c_f32_bf16 v240, v36, v36
    v_dot2c_f32_bf16 v241, v37, v9
    v_dot2c_f32_bf16 v240, v37, v37
    v_dot2c_f32_bf16 v241, v38, v9
    v_dot2c_f32_bf16 v240, v38, v38
    v_dot2c_f32_bf16 v241, v39, v9
    v_dot2c_f32_bf16 v240, v39, v39
    s_waitcnt vmcnt(6)
    v_dot2c_f32_bf16 v241, v44, v9
    v_dot2c_f32_bf16 v240, v44, v44
    v_dot2c_f32_bf16 v241, v45, v9
    v_dot2c_f32_bf16 v240, v45, v45
    v_dot2c_f32_bf16 v241, v46, v9
    buffer_load_dwordx4 v[84:87], v7, s[8:11], s86 offen offset:1024
    buffer_load_dwordx4 v[92:95], v7, s[8:11], s86 offen offset:1280
    v_dot2c_f32_bf16 v240, v46, v46
    v_dot2c_f32_bf16 v241, v47, v9
    v_dot2c_f32_bf16 v240, v47, v47
    v_lshlrev_b32 v16, 16, v20
    v_and_b32 v17, s0, v20
    v_lshlrev_b32 v18, 16, v21
    v_and_b32 v19, s0, v21
    v_lshlrev_b32 v20, 16, v22
    v_and_b32 v21, s0, v22
    v_lshlrev_b32 v22, 16, v23
    v_and_b32 v23, s0, v23
    v_lshlrev_b32 v24, 16, v28
    v_and_b32 v25, s0, v28
    v_lshlrev_b32 v26, 16, v29
    v_and_b32 v27, s0, v29
    v_lshlrev_b32 v28, 16, v30
    v_and_b32 v29, s0, v30
    v_lshlrev_b32 v30, 16, v31
    v_and_b32 v31, s0, v31
    v_lshlrev_b32 v32, 16, v36
    v_and_b32 v33, s0, v36
    v_lshlrev_b32 v34, 16, v37
    v_and_b32 v35, s0, v37
    v_lshlrev_b32 v36, 16, v38
    v_and_b32 v37, s0, v38
    v_lshlrev_b32 v38, 16, v39
    v_and_b32 v39, s0, v39
    v_lshlrev_b32 v40, 16, v44
    v_and_b32 v41, s0, v44
    buffer_load_dwordx4 v[100:103], v7, s[8:11], s86 offen offset:1536
    buffer_load_dwordx4 v[108:111], v7, s[8:11], s86 offen offset:1792
    v_lshlrev_b32 v42, 16, v45
    v_and_b32 v43, s0, v45
    v_lshlrev_b32 v44, 16, v46
    v_and_b32 v45, s0, v46
    v_lshlrev_b32 v46, 16, v47
    v_and_b32 v47, s0, v47
    s_waitcnt vmcnt(9)
    v_dot2c_f32_bf16 v243, v52, v9
    v_dot2c_f32_bf16 v242, v52, v52
    v_dot2c_f32_bf16 v243, v53, v9
    v_dot2c_f32_bf16 v242, v53, v53
    v_dot2c_f32_bf16 v243, v54, v9
    v_dot2c_f32_bf16 v242, v54, v54
    v_dot2c_f32_bf16 v243, v55, v9
    v_dot2c_f32_bf16 v242, v55, v55
    s_waitcnt vmcnt(8)
    v_dot2c_f32_bf16 v243, v60, v9
    v_dot2c_f32_bf16 v242, v60, v60
    v_dot2c_f32_bf16 v243, v61, v9
    v_dot2c_f32_bf16 v242, v61, v61
    v_dot2c_f32_bf16 v243, v62, v9
    v_dot2c_f32_bf16 v242, v62, v62
    v_dot2c_f32_bf16 v243, v63, v9
    v_dot2c_f32_bf16 v242, v63, v63
    s_waitcnt vmcnt(5)
    v_dot2c_f32_bf16 v243, v68, v9
    v_dot2c_f32_bf16 v242, v68, v68
    v_dot2c_f32_bf16 v243, v69, v9
    v_dot2c_f32_bf16 v242, v69, v69
    v_dot2c_f32_bf16 v243, v70, v9
    v_dot2c_f32_bf16 v242, v70, v70
    v_dot2c_f32_bf16 v243, v71, v9
    buffer_load_dwordx4 v[116:119], v7, s[8:11], s87 offen offset:0
    buffer_load_dwordx4 v[124:127], v7, s[8:11], s87 offen offset:256
    v_dot2c_f32_bf16 v242, v71, v71
    s_waitcnt vmcnt(6)
    v_dot2c_f32_bf16 v243, v76, v9
    v_dot2c_f32_bf16 v242, v76, v76
    v_dot2c_f32_bf16 v243, v77, v9
    v_dot2c_f32_bf16 v242, v77, v77
    v_dot2c_f32_bf16 v243, v78, v9
    v_dot2c_f32_bf16 v242, v78, v78
    v_dot2c_f32_bf16 v243, v79, v9
    v_dot2c_f32_bf16 v242, v79, v79
    v_lshlrev_b32 v48, 16, v52
    v_and_b32 v49, s0, v52
    v_lshlrev_b32 v50, 16, v53
    v_and_b32 v51, s0, v53
    v_lshlrev_b32 v52, 16, v54
    v_and_b32 v53, s0, v54
    v_lshlrev_b32 v54, 16, v55
    v_and_b32 v55, s0, v55
    v_lshlrev_b32 v56, 16, v60
    v_and_b32 v57, s0, v60
    v_lshlrev_b32 v58, 16, v61
    v_and_b32 v59, s0, v61
    v_lshlrev_b32 v60, 16, v62
    v_and_b32 v61, s0, v62
    v_lshlrev_b32 v62, 16, v63
    v_and_b32 v63, s0, v63
    v_lshlrev_b32 v64, 16, v68
    v_and_b32 v65, s0, v68
    v_lshlrev_b32 v66, 16, v69
    v_and_b32 v67, s0, v69
    buffer_load_dwordx4 v[132:135], v7, s[8:11], s87 offen offset:512
    buffer_load_dwordx4 v[140:143], v7, s[8:11], s87 offen offset:768
    v_lshlrev_b32 v68, 16, v70
    v_and_b32 v69, s0, v70
    v_lshlrev_b32 v70, 16, v71
    v_and_b32 v71, s0, v71
    v_lshlrev_b32 v72, 16, v76
    v_and_b32 v73, s0, v76
    v_lshlrev_b32 v74, 16, v77
    v_and_b32 v75, s0, v77
    v_lshlrev_b32 v76, 16, v78
    v_and_b32 v77, s0, v78
    v_lshlrev_b32 v78, 16, v79
    v_and_b32 v79, s0, v79
    s_waitcnt vmcnt(7)
    v_dot2c_f32_bf16 v245, v84, v9
    v_dot2c_f32_bf16 v244, v84, v84
    v_dot2c_f32_bf16 v245, v85, v9
    v_dot2c_f32_bf16 v244, v85, v85
    v_dot2c_f32_bf16 v245, v86, v9
    v_dot2c_f32_bf16 v244, v86, v86
    v_dot2c_f32_bf16 v245, v87, v9
    v_dot2c_f32_bf16 v244, v87, v87
    s_waitcnt vmcnt(6)
    v_dot2c_f32_bf16 v245, v92, v9
    v_dot2c_f32_bf16 v244, v92, v92
    v_dot2c_f32_bf16 v245, v93, v9
    v_dot2c_f32_bf16 v244, v93, v93
    v_dot2c_f32_bf16 v245, v94, v9
    v_dot2c_f32_bf16 v244, v94, v94
    v_dot2c_f32_bf16 v245, v95, v9
    v_dot2c_f32_bf16 v244, v95, v95
    s_waitcnt vmcnt(5)
    v_dot2c_f32_bf16 v245, v100, v9
    buffer_load_dwordx4 v[148:151], v7, s[8:11], s87 offen offset:1024
    buffer_load_dwordx4 v[156:159], v7, s[8:11], s87 offen offset:1280
    v_dot2c_f32_bf16 v244, v100, v100
    v_dot2c_f32_bf16 v245, v101, v9
    v_dot2c_f32_bf16 v244, v101, v101
    v_dot2c_f32_bf16 v245, v102, v9
    v_dot2c_f32_bf16 v244, v102, v102
    v_dot2c_f32_bf16 v245, v103, v9
    v_dot2c_f32_bf16 v244, v103, v103
    s_waitcnt vmcnt(6)
    v_dot2c_f32_bf16 v245, v108, v9
    v_dot2c_f32_bf16 v244, v108, v108
    v_dot2c_f32_bf16 v245, v109, v9
    v_dot2c_f32_bf16 v244, v109, v109
    v_dot2c_f32_bf16 v245, v110, v9
    v_dot2c_f32_bf16 v244, v110, v110
    v_dot2c_f32_bf16 v245, v111, v9
    v_dot2c_f32_bf16 v244, v111, v111
    v_lshlrev_b32 v80, 16, v84
    v_and_b32 v81, s0, v84
    v_lshlrev_b32 v82, 16, v85
    v_and_b32 v83, s0, v85
    v_lshlrev_b32 v84, 16, v86
    v_and_b32 v85, s0, v86
    v_lshlrev_b32 v86, 16, v87
    v_and_b32 v87, s0, v87
    v_lshlrev_b32 v88, 16, v92
    v_and_b32 v89, s0, v92
    v_lshlrev_b32 v90, 16, v93
    v_and_b32 v91, s0, v93
    v_lshlrev_b32 v92, 16, v94
    v_and_b32 v93, s0, v94
    buffer_load_dwordx4 v[164:167], v7, s[8:11], s87 offen offset:1536
    buffer_load_dwordx4 v[172:175], v7, s[8:11], s87 offen offset:1792
    v_lshlrev_b32 v94, 16, v95
    v_and_b32 v95, s0, v95
    v_lshlrev_b32 v96, 16, v100
    v_and_b32 v97, s0, v100
    v_lshlrev_b32 v98, 16, v101
    v_and_b32 v99, s0, v101
    v_lshlrev_b32 v100, 16, v102
    v_and_b32 v101, s0, v102
    v_lshlrev_b32 v102, 16, v103
    v_and_b32 v103, s0, v103
    v_lshlrev_b32 v104, 16, v108
    v_and_b32 v105, s0, v108
    v_lshlrev_b32 v106, 16, v109
    v_and_b32 v107, s0, v109
    v_lshlrev_b32 v108, 16, v110
    v_and_b32 v109, s0, v110
    v_lshlrev_b32 v110, 16, v111
    v_and_b32 v111, s0, v111
    s_waitcnt vmcnt(7)
    v_dot2c_f32_bf16 v247, v116, v9
    v_dot2c_f32_bf16 v246, v116, v116
    v_dot2c_f32_bf16 v247, v117, v9
    v_dot2c_f32_bf16 v246, v117, v117
    v_dot2c_f32_bf16 v247, v118, v9
    v_dot2c_f32_bf16 v246, v118, v118
    v_dot2c_f32_bf16 v247, v119, v9
    v_dot2c_f32_bf16 v246, v119, v119
    s_waitcnt vmcnt(6)
    v_dot2c_f32_bf16 v247, v124, v9
    v_dot2c_f32_bf16 v246, v124, v124
    v_dot2c_f32_bf16 v247, v125, v9
    s_add_u32 s83, s82, 0
    s_and_b32 s83, s83, 3
    s_mul_i32 s83, s83, 393216
    s_add_u32 m0, s84, 0
    s_nop 0
    buffer_load_dwordx4 v3, s[12:15], s83 offen offset:0 lds
    buffer_load_dwordx4 v4, s[12:15], s83 offen offset:1024 lds
    v_dot2c_f32_bf16 v246, v125, v125
    v_dot2c_f32_bf16 v247, v126, v9
    v_dot2c_f32_bf16 v246, v126, v126
    v_dot2c_f32_bf16 v247, v127, v9
    v_dot2c_f32_bf16 v246, v127, v127
    s_waitcnt vmcnt(7)
    v_dot2c_f32_bf16 v247, v132, v9
    v_dot2c_f32_bf16 v246, v132, v132
    v_dot2c_f32_bf16 v247, v133, v9
    v_dot2c_f32_bf16 v246, v133, v133
    v_dot2c_f32_bf16 v247, v134, v9
    v_dot2c_f32_bf16 v246, v134, v134
    v_dot2c_f32_bf16 v247, v135, v9
    v_dot2c_f32_bf16 v246, v135, v135
    s_waitcnt vmcnt(6)
    v_dot2c_f32_bf16 v247, v140, v9
    v_dot2c_f32_bf16 v246, v140, v140
    v_dot2c_f32_bf16 v247, v141, v9
    v_dot2c_f32_bf16 v246, v141, v141
    v_dot2c_f32_bf16 v247, v142, v9
    v_dot2c_f32_bf16 v246, v142, v142
    v_dot2c_f32_bf16 v247, v143, v9
    v_dot2c_f32_bf16 v246, v143, v143
    v_lshlrev_b32 v112, 16, v116
    v_and_b32 v113, s0, v116
    v_lshlrev_b32 v114, 16, v117
    v_and_b32 v115, s0, v117
    v_lshlrev_b32 v116, 16, v118
    v_and_b32 v117, s0, v118
    v_lshlrev_b32 v118, 16, v119
    v_and_b32 v119, s0, v119
    buffer_load_dwordx4 v5, s[12:15], s83 offen offset:2048 lds
    buffer_load_dwordx4 v6, s[12:15], s83 offen offset:3072 lds
    v_lshlrev_b32 v120, 16, v124
    v_and_b32 v121, s0, v124
    v_lshlrev_b32 v122, 16, v125
    v_and_b32 v123, s0, v125
    v_lshlrev_b32 v124, 16, v126
    v_and_b32 v125, s0, v126
    v_lshlrev_b32 v126, 16, v127
    v_and_b32 v127, s0, v127
    v_lshlrev_b32 v128, 16, v132
    v_and_b32 v129, s0, v132
    v_lshlrev_b32 v130, 16, v133
    v_and_b32 v131, s0, v133
    v_lshlrev_b32 v132, 16, v134
    v_and_b32 v133, s0, v134
    v_lshlrev_b32 v134, 16, v135
    v_and_b32 v135, s0, v135
    v_lshlrev_b32 v136, 16, v140
    v_and_b32 v137, s0, v140
    v_lshlrev_b32 v138, 16, v141
    v_and_b32 v139, s0, v141
    v_lshlrev_b32 v140, 16, v142
    v_and_b32 v141, s0, v142
    v_lshlrev_b32 v142, 16, v143
    v_and_b32 v143, s0, v143
    s_waitcnt vmcnt(7)
    v_dot2c_f32_bf16 v249, v148, v9
    v_dot2c_f32_bf16 v248, v148, v148
    v_dot2c_f32_bf16 v249, v149, v9
    v_dot2c_f32_bf16 v248, v149, v149
    v_dot2c_f32_bf16 v249, v150, v9
    s_add_u32 s83, s83, 1024
    s_add_u32 m0, s84, 16384
    s_nop 0
    buffer_load_dwordx4 v3, s[12:15], s83 offen offset:0 lds
    buffer_load_dwordx4 v4, s[12:15], s83 offen offset:1024 lds
    v_dot2c_f32_bf16 v248, v150, v150
    v_dot2c_f32_bf16 v249, v151, v9
    v_dot2c_f32_bf16 v248, v151, v151
    s_waitcnt vmcnt(8)
    v_dot2c_f32_bf16 v249, v156, v9
    v_dot2c_f32_bf16 v248, v156, v156
    v_dot2c_f32_bf16 v249, v157, v9
    v_dot2c_f32_bf16 v248, v157, v157
    v_dot2c_f32_bf16 v249, v158, v9
    v_dot2c_f32_bf16 v248, v158, v158
    v_dot2c_f32_bf16 v249, v159, v9
    v_dot2c_f32_bf16 v248, v159, v159
    s_waitcnt vmcnt(7)
    v_dot2c_f32_bf16 v249, v164, v9
    v_dot2c_f32_bf16 v248, v164, v164
    v_dot2c_f32_bf16 v249, v165, v9
    v_dot2c_f32_bf16 v248, v165, v165
    v_dot2c_f32_bf16 v249, v166, v9
    v_dot2c_f32_bf16 v248, v166, v166
    v_dot2c_f32_bf16 v249, v167, v9
    v_dot2c_f32_bf16 v248, v167, v167
    s_waitcnt vmcnt(6)
    v_dot2c_f32_bf16 v249, v172, v9
    v_dot2c_f32_bf16 v248, v172, v172
    v_dot2c_f32_bf16 v249, v173, v9
    v_dot2c_f32_bf16 v248, v173, v173
    v_dot2c_f32_bf16 v249, v174, v9
    v_dot2c_f32_bf16 v248, v174, v174
    v_dot2c_f32_bf16 v249, v175, v9
    v_dot2c_f32_bf16 v248, v175, v175
    v_lshlrev_b32 v144, 16, v148
    v_and_b32 v145, s0, v148
    buffer_load_dwordx4 v5, s[12:15], s83 offen offset:2048 lds
    buffer_load_dwordx4 v6, s[12:15], s83 offen offset:3072 lds
    v_lshlrev_b32 v146, 16, v149
    v_and_b32 v147, s0, v149
    v_lshlrev_b32 v148, 16, v150
    v_and_b32 v149, s0, v150
    v_lshlrev_b32 v150, 16, v151
    v_and_b32 v151, s0, v151
    v_lshlrev_b32 v152, 16, v156
    v_and_b32 v153, s0, v156
    v_lshlrev_b32 v154, 16, v157
    v_and_b32 v155, s0, v157
    v_lshlrev_b32 v156, 16, v158
    v_and_b32 v157, s0, v158
    v_lshlrev_b32 v158, 16, v159
    v_and_b32 v159, s0, v159
    v_lshlrev_b32 v160, 16, v164
    v_and_b32 v161, s0, v164
    v_lshlrev_b32 v162, 16, v165
    v_and_b32 v163, s0, v165
    v_lshlrev_b32 v164, 16, v166
    v_and_b32 v165, s0, v166
    v_lshlrev_b32 v166, 16, v167
    v_and_b32 v167, s0, v167
    v_lshlrev_b32 v168, 16, v172
    v_and_b32 v169, s0, v172
    v_lshlrev_b32 v170, 16, v173
    v_and_b32 v171, s0, v173
    v_lshlrev_b32 v172, 16, v174
    v_and_b32 v173, s0, v174
    v_lshlrev_b32 v174, 16, v175
    v_and_b32 v175, s0, v175
    s_mov_b32 s85, 589824
    s_mov_b32 s86, 602112
    s_mov_b32 s87, 614400
    s_mov_b32 s93, 626688
    s_mov_b32 s40, 0x0c0c0400
    s_add_u32 s83, s83, 1024
    s_add_u32 m0, s84, 32768
    s_nop 0
    buffer_load_dwordx4 v3, s[12:15], s83 offen offset:0 lds
    buffer_load_dwordx4 v4, s[12:15], s83 offen offset:1024 lds
    v_add_f32_dpp v240, v240, v240 row_ror:8 row_mask:0xf bank_mask:0xf
    v_add_f32_dpp v241, v241, v241 row_ror:8 row_mask:0xf bank_mask:0xf
    v_add_f32_dpp v242, v242, v242 row_ror:8 row_mask:0xf bank_mask:0xf
    v_add_f32_dpp v243, v243, v243 row_ror:8 row_mask:0xf bank_mask:0xf
    v_add_f32_dpp v244, v244, v244 row_ror:8 row_mask:0xf bank_mask:0xf
    v_add_f32_dpp v245, v245, v245 row_ror:8 row_mask:0xf bank_mask:0xf
    v_add_f32_dpp v246, v246, v246 row_ror:8 row_mask:0xf bank_mask:0xf
    v_add_f32_dpp v247, v247, v247 row_ror:8 row_mask:0xf bank_mask:0xf
    v_add_f32_dpp v248, v248, v248 row_ror:8 row_mask:0xf bank_mask:0xf
    v_add_f32_dpp v249, v249, v249 row_ror:8 row_mask:0xf bank_mask:0xf
    v_add_f32_dpp v240, v240, v240 row_ror:4 row_mask:0xf bank_mask:0xf
    v_add_f32_dpp v241, v241, v241 row_ror:4 row_mask:0xf bank_mask:0xf
    v_add_f32_dpp v242, v242, v242 row_ror:4 row_mask:0xf bank_mask:0xf
    v_add_f32_dpp v243, v243, v243 row_ror:4 row_mask:0xf bank_mask:0xf
    buffer_load_dwordx4 v5, s[12:15], s83 offen offset:2048 lds
    buffer_load_dwordx4 v6, s[12:15], s83 offen offset:3072 lds
    v_add_f32_dpp v244, v244, v244 row_ror:4 row_mask:0xf bank_mask:0xf
    v_add_f32_dpp v245, v245, v245 row_ror:4 row_mask:0xf bank_mask:0xf
    v_add_f32_dpp v246, v246, v246 row_ror:4 row_mask:0xf bank_mask:0xf
    v_add_f32_dpp v247, v247, v247 row_ror:4 row_mask:0xf bank_mask:0xf
    v_add_f32_dpp v248, v248, v248 row_ror:4 row_mask:0xf bank_mask:0xf
    v_add_f32_dpp v249, v249, v249 row_ror:4 row_mask:0xf bank_mask:0xf
    v_add_f32_dpp v240, v240, v240 row_ror:2 row_mask:0xf bank_mask:0xf
    v_add_f32_dpp v241, v241, v241 row_ror:2 row_mask:0xf bank_mask:0xf
    v_add_f32_dpp v242, v242, v242 row_ror:2 row_mask:0xf bank_mask:0xf
    v_add_f32_dpp v243, v243, v243 row_ror:2 row_mask:0xf bank_mask:0xf
    v_add_f32_dpp v244, v244, v244 row_ror:2 row_mask:0xf bank_mask:0xf
    v_add_f32_dpp v245, v245, v245 row_ror:2 row_mask:0xf bank_mask:0xf
    v_add_f32_dpp v246, v246, v246 row_ror:2 row_mask:0xf bank_mask:0xf
    v_add_f32_dpp v247, v247, v247 row_ror:2 row_mask:0xf bank_mask:0xf
    v_add_f32_dpp v248, v248, v248 row_ror:2 row_mask:0xf bank_mask:0xf
    s_add_u32 s83, s82, 1
    s_and_b32 s83, s83, 3
    s_mul_i32 s83, s83, 393216
    s_add_u32 m0, s84, 49152
    s_nop 0
    buffer_load_dwordx4 v3, s[12:15], s83 offen offset:0 lds
    buffer_load_dwordx4 v4, s[12:15], s83 offen offset:1024 lds
    v_add_f32_dpp v249, v249, v249 row_ror:2 row_mask:0xf bank_mask:0xf
    v_add_f32_dpp v240, v240, v240 row_ror:1 row_mask:0xf bank_mask:0xf
    v_add_f32_dpp v241, v241, v241 row_ror:1 row_mask:0xf bank_mask:0xf
    v_add_f32_dpp v242, v242, v242 row_ror:1 row_mask:0xf bank_mask:0xf
    v_add_f32_dpp v243, v243, v243 row_ror:1 row_mask:0xf bank_mask:0xf
    v_add_f32_dpp v244, v244, v244 row_ror:1 row_mask:0xf bank_mask:0xf
    v_add_f32_dpp v245, v245, v245 row_ror:1 row_mask:0xf bank_mask:0xf
    v_add_f32_dpp v246, v246, v246 row_ror:1 row_mask:0xf bank_mask:0xf
    v_add_f32_dpp v247, v247, v247 row_ror:1 row_mask:0xf bank_mask:0xf
    v_add_f32_dpp v248, v248, v248 row_ror:1 row_mask:0xf bank_mask:0xf
    v_add_f32_dpp v249, v249, v249 row_ror:1 row_mask:0xf bank_mask:0xf
    s_mov_b32 s94, 0x3b000000
    v_mov_b32 v9, 0x3727c5ac
    v_mul_f32 v241, s94, v241
    v_fma_f32 v240, v240, s94, v9
    buffer_load_dwordx4 v5, s[12:15], s83 offen offset:2048 lds
    buffer_load_dwordx4 v6, s[12:15], s83 offen offset:3072 lds
    v_mul_f32 v243, s94, v243
    v_fma_f32 v242, v242, s94, v9
    v_mul_f32 v245, s94, v245
    v_fma_f32 v244, v244, s94, v9
    v_mul_f32 v247, s94, v247
    v_fma_f32 v246, v246, s94, v9
    v_mul_f32 v249, s94, v249
    v_fma_f32 v248, v248, s94, v9
    v_fma_f32 v240, -v241, v241, v240
    v_fma_f32 v242, -v243, v243, v242
    v_fma_f32 v244, -v245, v245, v244
    v_fma_f32 v246, -v247, v247, v246
    v_fma_f32 v248, -v249, v249, v248
    v_rsq_f32 v240, v240
    s_add_u32 s83, s83, 1024
    s_add_u32 m0, s84, 65536
    s_nop 0
    buffer_load_dwordx4 v3, s[12:15], s83 offen offset:0 lds
    buffer_load_dwordx4 v4, s[12:15], s83 offen offset:1024 lds
    v_rsq_f32 v242, v242
    v_rsq_f32 v244, v244
    v_rsq_f32 v246, v246
    v_rsq_f32 v248, v248
    v_mul_f32 v241, -v241, v240
    v_mul_f32 v243, -v243, v242
    v_mul_f32 v245, -v245, v244
    v_mul_f32 v247, -v247, v246
    v_mul_f32 v249, -v249, v248
    v_pk_fma_f32 v[16:17], v[16:17], v[240:241], v[240:241] op_sel:[0,0,1] op_sel_hi:[1,0,1]
    v_pk_fma_f32 v[18:19], v[18:19], v[240:241], v[240:241] op_sel:[0,0,1] op_sel_hi:[1,0,1]
    v_pk_fma_f32 v[20:21], v[20:21], v[240:241], v[240:241] op_sel:[0,0,1] op_sel_hi:[1,0,1]
    v_pk_fma_f32 v[22:23], v[22:23], v[240:241], v[240:241] op_sel:[0,0,1] op_sel_hi:[1,0,1]
    v_pk_fma_f32 v[24:25], v[24:25], v[240:241], v[240:241] op_sel:[0,0,1] op_sel_hi:[1,0,1]
    v_pk_fma_f32 v[26:27], v[26:27], v[240:241], v[240:241] op_sel:[0,0,1] op_sel_hi:[1,0,1]
    buffer_load_dwordx4 v5, s[12:15], s83 offen offset:2048 lds
    buffer_load_dwordx4 v6, s[12:15], s83 offen offset:3072 lds
    v_pk_fma_f32 v[28:29], v[28:29], v[240:241], v[240:241] op_sel:[0,0,1] op_sel_hi:[1,0,1]
    v_pk_fma_f32 v[30:31], v[30:31], v[240:241], v[240:241] op_sel:[0,0,1] op_sel_hi:[1,0,1]
    v_pk_fma_f32 v[32:33], v[32:33], v[240:241], v[240:241] op_sel:[0,0,1] op_sel_hi:[1,0,1]
    v_pk_fma_f32 v[34:35], v[34:35], v[240:241], v[240:241] op_sel:[0,0,1] op_sel_hi:[1,0,1]
    v_pk_fma_f32 v[36:37], v[36:37], v[240:241], v[240:241] op_sel:[0,0,1] op_sel_hi:[1,0,1]
    v_pk_fma_f32 v[38:39], v[38:39], v[240:241], v[240:241] op_sel:[0,0,1] op_sel_hi:[1,0,1]
    v_pk_fma_f32 v[40:41], v[40:41], v[240:241], v[240:241] op_sel:[0,0,1] op_sel_hi:[1,0,1]
    v_pk_fma_f32 v[42:43], v[42:43], v[240:241], v[240:241] op_sel:[0,0,1] op_sel_hi:[1,0,1]
    v_pk_fma_f32 v[44:45], v[44:45], v[240:241], v[240:241] op_sel:[0,0,1] op_sel_hi:[1,0,1]
    v_pk_fma_f32 v[46:47], v[46:47], v[240:241], v[240:241] op_sel:[0,0,1] op_sel_hi:[1,0,1]
    v_pk_fma_f32 v[48:49], v[48:49], v[242:243], v[242:243] op_sel:[0,0,1] op_sel_hi:[1,0,1]
    v_pk_fma_f32 v[50:51], v[50:51], v[242:243], v[242:243] op_sel:[0,0,1] op_sel_hi:[1,0,1]
    v_pk_fma_f32 v[52:53], v[52:53], v[242:243], v[242:243] op_sel:[0,0,1] op_sel_hi:[1,0,1]
    v_pk_fma_f32 v[54:55], v[54:55], v[242:243], v[242:243] op_sel:[0,0,1] op_sel_hi:[1,0,1]
    v_pk_fma_f32 v[56:57], v[56:57], v[242:243], v[242:243] op_sel:[0,0,1] op_sel_hi:[1,0,1]
    s_add_u32 s83, s83, 1024
    s_add_u32 m0, s84, 81920
    s_nop 0
    buffer_load_dwordx4 v3, s[12:15], s83 offen offset:0 lds
    buffer_load_dwordx4 v4, s[12:15], s83 offen offset:1024 lds
    v_pk_fma_f32 v[58:59], v[58:59], v[242:243], v[242:243] op_sel:[0,0,1] op_sel_hi:[1,0,1]
    v_pk_fma_f32 v[60:61], v[60:61], v[242:243], v[242:243] op_sel:[0,0,1] op_sel_hi:[1,0,1]
    v_pk_fma_f32 v[62:63], v[62:63], v[242:243], v[242:243] op_sel:[0,0,1] op_sel_hi:[1,0,1]
    v_pk_fma_f32 v[64:65], v[64:65], v[242:243], v[242:243] op_sel:[0,0,1] op_sel_hi:[1,0,1]
    v_pk_fma_f32 v[66:67], v[66:67], v[242:243], v[242:243] op_sel:[0,0,1] op_sel_hi:[1,0,1]
    v_pk_fma_f32 v[68:69], v[68:69], v[242:243], v[242:243] op_sel:[0,0,1] op_sel_hi:[1,0,1]
    v_pk_fma_f32 v[70:71], v[70:71], v[242:243], v[242:243] op_sel:[0,0,1] op_sel_hi:[1,0,1]
    v_pk_fma_f32 v[72:73], v[72:73], v[242:243], v[242:243] op_sel:[0,0,1] op_sel_hi:[1,0,1]
    v_pk_fma_f32 v[74:75], v[74:75], v[242:243], v[242:243] op_sel:[0,0,1] op_sel_hi:[1,0,1]
    v_pk_fma_f32 v[76:77], v[76:77], v[242:243], v[242:243] op_sel:[0,0,1] op_sel_hi:[1,0,1]
    v_pk_fma_f32 v[78:79], v[78:79], v[242:243], v[242:243] op_sel:[0,0,1] op_sel_hi:[1,0,1]
    v_pk_fma_f32 v[80:81], v[80:81], v[244:245], v[244:245] op_sel:[0,0,1] op_sel_hi:[1,0,1]
    v_pk_fma_f32 v[82:83], v[82:83], v[244:245], v[244:245] op_sel:[0,0,1] op_sel_hi:[1,0,1]
    v_pk_fma_f32 v[84:85], v[84:85], v[244:245], v[244:245] op_sel:[0,0,1] op_sel_hi:[1,0,1]
    buffer_load_dwordx4 v[176:179], v2, s[36:39], s85 offen sc1
    buffer_load_dwordx4 v[180:183], v2, s[36:39], s86 offen sc1
    v_pk_fma_f32 v[86:87], v[86:87], v[244:245], v[244:245] op_sel:[0,0,1] op_sel_hi:[1,0,1]
    v_pk_fma_f32 v[88:89], v[88:89], v[244:245], v[244:245] op_sel:[0,0,1] op_sel_hi:[1,0,1]
    v_pk_fma_f32 v[90:91], v[90:91], v[244:245], v[244:245] op_sel:[0,0,1] op_sel_hi:[1,0,1]
    v_pk_fma_f32 v[92:93], v[92:93], v[244:245], v[244:245] op_sel:[0,0,1] op_sel_hi:[1,0,1]
    v_pk_fma_f32 v[94:95], v[94:95], v[244:245], v[244:245] op_sel:[0,0,1] op_sel_hi:[1,0,1]
    v_pk_fma_f32 v[96:97], v[96:97], v[244:245], v[244:245] op_sel:[0,0,1] op_sel_hi:[1,0,1]
    v_pk_fma_f32 v[98:99], v[98:99], v[244:245], v[244:245] op_sel:[0,0,1] op_sel_hi:[1,0,1]
    v_pk_fma_f32 v[100:101], v[100:101], v[244:245], v[244:245] op_sel:[0,0,1] op_sel_hi:[1,0,1]
    v_pk_fma_f32 v[102:103], v[102:103], v[244:245], v[244:245] op_sel:[0,0,1] op_sel_hi:[1,0,1]
    v_pk_fma_f32 v[104:105], v[104:105], v[244:245], v[244:245] op_sel:[0,0,1] op_sel_hi:[1,0,1]
    v_pk_fma_f32 v[106:107], v[106:107], v[244:245], v[244:245] op_sel:[0,0,1] op_sel_hi:[1,0,1]
    v_pk_fma_f32 v[108:109], v[108:109], v[244:245], v[244:245] op_sel:[0,0,1] op_sel_hi:[1,0,1]
    v_pk_fma_f32 v[110:111], v[110:111], v[244:245], v[244:245] op_sel:[0,0,1] op_sel_hi:[1,0,1]
    v_pk_fma_f32 v[112:113], v[112:113], v[246:247], v[246:247] op_sel:[0,0,1] op_sel_hi:[1,0,1]
    v_pk_fma_f32 v[114:115], v[114:115], v[246:247], v[246:247] op_sel:[0,0,1] op_sel_hi:[1,0,1]
    buffer_load_dwordx4 v[184:187], v2, s[36:39], s87 offen sc1
    buffer_load_dwordx4 v[188:191], v2, s[36:39], s93 offen sc1
    v_pk_fma_f32 v[116:117], v[116:117], v[246:247], v[246:247] op_sel:[0,0,1] op_sel_hi:[1,0,1]
    v_pk_fma_f32 v[118:119], v[118:119], v[246:247], v[246:247] op_sel:[0,0,1] op_sel_hi:[1,0,1]
    v_pk_fma_f32 v[120:121], v[120:121], v[246:247], v[246:247] op_sel:[0,0,1] op_sel_hi:[1,0,1]
    v_pk_fma_f32 v[122:123], v[122:123], v[246:247], v[246:247] op_sel:[0,0,1] op_sel_hi:[1,0,1]
    v_pk_fma_f32 v[124:125], v[124:125], v[246:247], v[246:247] op_sel:[0,0,1] op_sel_hi:[1,0,1]
    v_pk_fma_f32 v[126:127], v[126:127], v[246:247], v[246:247] op_sel:[0,0,1] op_sel_hi:[1,0,1]
    v_pk_fma_f32 v[128:129], v[128:129], v[246:247], v[246:247] op_sel:[0,0,1] op_sel_hi:[1,0,1]
    v_pk_fma_f32 v[130:131], v[130:131], v[246:247], v[246:247] op_sel:[0,0,1] op_sel_hi:[1,0,1]
    v_pk_fma_f32 v[132:133], v[132:133], v[246:247], v[246:247] op_sel:[0,0,1] op_sel_hi:[1,0,1]
    v_pk_fma_f32 v[134:135], v[134:135], v[246:247], v[246:247] op_sel:[0,0,1] op_sel_hi:[1,0,1]
    v_pk_fma_f32 v[136:137], v[136:137], v[246:247], v[246:247] op_sel:[0,0,1] op_sel_hi:[1,0,1]
    v_pk_fma_f32 v[138:139], v[138:139], v[246:247], v[246:247] op_sel:[0,0,1] op_sel_hi:[1,0,1]
    v_pk_fma_f32 v[140:141], v[140:141], v[246:247], v[246:247] op_sel:[0,0,1] op_sel_hi:[1,0,1]
    v_pk_fma_f32 v[142:143], v[142:143], v[246:247], v[246:247] op_sel:[0,0,1] op_sel_hi:[1,0,1]
    v_pk_fma_f32 v[144:145], v[144:145], v[248:249], v[248:249] op_sel:[0,0,1] op_sel_hi:[1,0,1]
    buffer_load_dwordx4 v5, s[12:15], s83 offen offset:2048 lds
    buffer_load_dwordx4 v6, s[12:15], s83 offen offset:3072 lds
    v_pk_fma_f32 v[146:147], v[146:147], v[248:249], v[248:249] op_sel:[0,0,1] op_sel_hi:[1,0,1]
    v_pk_fma_f32 v[148:149], v[148:149], v[248:249], v[248:249] op_sel:[0,0,1] op_sel_hi:[1,0,1]
    v_pk_fma_f32 v[150:151], v[150:151], v[248:249], v[248:249] op_sel:[0,0,1] op_sel_hi:[1,0,1]
    v_pk_fma_f32 v[152:153], v[152:153], v[248:249], v[248:249] op_sel:[0,0,1] op_sel_hi:[1,0,1]
    v_pk_fma_f32 v[154:155], v[154:155], v[248:249], v[248:249] op_sel:[0,0,1] op_sel_hi:[1,0,1]
    v_pk_fma_f32 v[156:157], v[156:157], v[248:249], v[248:249] op_sel:[0,0,1] op_sel_hi:[1,0,1]
    v_pk_fma_f32 v[158:159], v[158:159], v[248:249], v[248:249] op_sel:[0,0,1] op_sel_hi:[1,0,1]
    v_pk_fma_f32 v[160:161], v[160:161], v[248:249], v[248:249] op_sel:[0,0,1] op_sel_hi:[1,0,1]
    v_pk_fma_f32 v[162:163], v[162:163], v[248:249], v[248:249] op_sel:[0,0,1] op_sel_hi:[1,0,1]
    v_pk_fma_f32 v[164:165], v[164:165], v[248:249], v[248:249] op_sel:[0,0,1] op_sel_hi:[1,0,1]
    v_pk_fma_f32 v[166:167], v[166:167], v[248:249], v[248:249] op_sel:[0,0,1] op_sel_hi:[1,0,1]
    v_pk_fma_f32 v[168:169], v[168:169], v[248:249], v[248:249] op_sel:[0,0,1] op_sel_hi:[1,0,1]
    v_pk_fma_f32 v[170:171], v[170:171], v[248:249], v[248:249] op_sel:[0,0,1] op_sel_hi:[1,0,1]
    v_pk_fma_f32 v[172:173], v[172:173], v[248:249], v[248:249] op_sel:[0,0,1] op_sel_hi:[1,0,1]
    v_pk_fma_f32 v[174:175], v[174:175], v[248:249], v[248:249] op_sel:[0,0,1] op_sel_hi:[1,0,1]
    s_cmp_ge_u32 s5, 2
    s_cselect_b32 s41, 1.0, 0
    s_lshl_b32 s94, s5, 10
    s_add_u32 s94, s94, 147456
    v_lshrrev_b32 v9, 5, v0
    v_lshlrev_b32 v9, 1, v9
    v_and_b32 v10, 1, v0
    v_or_b32 v9, v9, v10
    v_lshlrev_b32 v9, 4, v9
    v_bfe_u32 v10, v0, 1, 4
    v_or_b32 v9, v9, v10
    v_lshl_add_u32 v11, v9, 4, s94
    v_and_b32 v10, 15, v0
    v_lshlrev_b32 v10, 4, v10
    v_add_u32 v10, 147456, v10
    s_waitcnt vmcnt(16)
    s_barrier
    s_add_u32 s83, s82, 2
    s_and_b32 s83, s83, 3
    s_mul_i32 s83, s83, 393216
    s_add_u32 m0, s84, 98304
    s_nop 0
    buffer_load_dwordx4 v3, s[12:15], s83 offen offset:0 lds
    buffer_load_dwordx4 v4, s[12:15], s83 offen offset:1024 lds
    ds_read_b64_tr_b16 a[0:1], v12 offset:0
    ds_read_b64_tr_b16 a[2:3], v12 offset:512
    ds_read_b64_tr_b16 a[64:65], v12 offset:16384
    ds_read_b64_tr_b16 a[66:67], v12 offset:16896
    ds_read_b64_tr_b16 a[128:129], v12 offset:32768
    ds_read_b64_tr_b16 a[130:131], v12 offset:33280
    ds_read_b64_tr_b16 a[4:5], v12 offset:4096
    ds_read_b64_tr_b16 a[6:7], v12 offset:4608
    buffer_load_dwordx4 v5, s[12:15], s83 offen offset:2048 lds
    buffer_load_dwordx4 v6, s[12:15], s83 offen offset:3072 lds
    ds_read_b64_tr_b16 a[68:69], v12 offset:20480
    ds_read_b64_tr_b16 a[70:71], v12 offset:20992
    ds_read_b64_tr_b16 a[132:133], v12 offset:36864
    ds_read_b64_tr_b16 a[134:135], v12 offset:37376
    ds_read_b64_tr_b16 a[8:9], v12 offset:8192
    ds_read_b64_tr_b16 a[10:11], v12 offset:8704
    ds_read_b64_tr_b16 a[72:73], v12 offset:24576
    ds_read_b64_tr_b16 a[74:75], v12 offset:25088
    s_add_u32 s83, s83, 1024
    s_add_u32 m0, s84, 114688
    s_nop 0
    buffer_load_dwordx4 v3, s[12:15], s83 offen offset:0 lds
    buffer_load_dwordx4 v4, s[12:15], s83 offen offset:1024 lds
    ds_read_b64_tr_b16 a[136:137], v12 offset:40960
    ds_read_b64_tr_b16 a[138:139], v12 offset:41472
    ds_read_b64_tr_b16 a[12:13], v12 offset:12288
    ds_read_b64_tr_b16 a[14:15], v12 offset:12800
    ds_read_b64_tr_b16 a[76:77], v12 offset:28672
    ds_read_b64_tr_b16 a[78:79], v12 offset:29184
    ds_read_b64_tr_b16 a[140:141], v12 offset:45056
    ds_read_b64_tr_b16 a[142:143], v12 offset:45568
    s_waitcnt vmcnt(8)
    v_perm_b32 v192, v177, v176, s40
    v_perm_b32 v193, v179, v178, s40
    v_perm_b32 v194, v181, v180, s40
    v_perm_b32 v195, v183, v182, s40
    v_perm_b32 v196, v185, v184, s40
    v_perm_b32 v197, v187, v186, s40
    v_perm_b32 v198, v189, v188, s40
    v_perm_b32 v199, v191, v190, s40
    v_lshl_or_b32 v192, v193, 16, v192
    v_lshl_or_b32 v194, v195, 16, v194
    v_lshl_or_b32 v196, v197, 16, v196
    v_lshl_or_b32 v198, v199, 16, v198
    v_min3_u32 v193, v192, v194, v196
    v_max3_u32 v195, v192, v194, v196
    v_min_u32 v193, v193, v198
    v_max_u32 v195, v195, v198
    v_cmp_ne_u32 vcc, s6, v193
    v_cmp_ne_u32 s[98:99], s6, v195
    s_nop 0
    s_or_b64 vcc, vcc, s[98:99]
    s_cbranch_vccnz L_spin1
L_back1:
    buffer_load_dwordx4 v5, s[12:15], s83 offen offset:2048 lds
    buffer_load_dwordx4 v6, s[12:15], s83 offen offset:3072 lds
    v_and_b32 v176, 0xffffff00, v176
    v_and_b32 v177, 0xffffff00, v177
    v_and_b32 v178, 0xffffff00, v178
    v_and_b32 v179, 0xffffff00, v179
    v_and_b32 v180, 0xffffff00, v180
    v_and_b32 v181, 0xffffff00, v181
    v_and_b32 v182, 0xffffff00, v182
    v_and_b32 v183, 0xffffff00, v183
    v_and_b32 v184, 0xffffff00, v184
    v_and_b32 v185, 0xffffff00, v185
    v_and_b32 v186, 0xffffff00, v186
    v_and_b32 v187, 0xffffff00, v187
    v_and_b32 v188, 0xffffff00, v188
    v_and_b32 v189, 0xffffff00, v189
    v_and_b32 v190, 0xffffff00, v190
    s_add_u32 s83, s83, 1024
    s_add_u32 m0, s84, 131072
    s_nop 0
    buffer_load_dwordx4 v3, s[12:15], s83 offen offset:0 lds
    buffer_load_dwordx4 v4, s[12:15], s83 offen offset:1024 lds
    v_and_b32 v191, 0xffffff00, v191
    v_add_f32 v176, v176, v180
    v_add_f32 v177, v177, v181
    v_add_f32 v178, v178, v182
    v_add_f32 v179, v179, v183
    v_add_f32 v184, v184, v188
    v_add_f32 v185, v185, v189
    v_add_f32 v186, v186, v190
    v_add_f32 v187, v187, v191
    v_add_f32 v176, v176, v184
    v_add_f32 v177, v177, v185
    v_add_f32 v178, v178, v186
    v_add_f32 v179, v179, v187
    v_cvt_pk_bf16_f32 v180, v176, v177
    v_cvt_pk_bf16_f32 v181, v178, v179
    buffer_load_dwordx4 v5, s[12:15], s83 offen offset:2048 lds
    buffer_load_dwordx4 v6, s[12:15], s83 offen offset:3072 lds
    v_lshlrev_b32 v176, 16, v180
    v_and_b32 v177, s0, v180
    v_lshlrev_b32 v178, 16, v181
    v_and_b32 v179, s0, v181
    v_add_f32 v176, s41, v176
    v_add_f32 v177, s41, v177
    v_add_f32 v178, s41, v178
    v_add_f32 v179, s41, v179
    v_cvt_pk_bf16_f32 v180, v176, v177
    v_cvt_pk_bf16_f32 v181, v178, v179
    v_lshlrev_b32 v176, 16, v180
    v_and_b32 v177, s0, v180
    v_lshlrev_b32 v178, 16, v181
    v_and_b32 v179, s0, v181
    ds_write_b128 v11, v[176:179]
    s_waitcnt vmcnt(12)
    s_waitcnt lgkmcnt(0)
    s_barrier
    ds_read_b128 v[176:179], v10 offset:2048
    ds_read_b128 v[184:187], v10 offset:0
    ds_read_b128 v[180:183], v10 offset:2304
    ds_read_b128 v[188:191], v10 offset:256
    ds_read_b128 v[192:195], v10 offset:2560
    ds_read_b128 v[200:203], v10 offset:512
    ds_read_b128 v[196:199], v10 offset:2816
    ds_read_b128 v[204:207], v10 offset:768
    s_add_u32 s83, s82, 3
    s_and_b32 s83, s83, 3
    s_mul_i32 s83, s83, 393216
    s_add_u32 m0, s84, 0
    s_nop 0
    buffer_load_dwordx4 v3, s[12:15], s83 offen offset:0 lds
    buffer_load_dwordx4 v4, s[12:15], s83 offen offset:1024 lds
    ds_read_b64_tr_b16 a[16:17], v13 offset:0
    ds_read_b64_tr_b16 a[18:19], v13 offset:512
    ds_read_b64_tr_b16 a[80:81], v13 offset:16384
    ds_read_b64_tr_b16 a[82:83], v13 offset:16896
    ds_read_b64_tr_b16 a[144:145], v13 offset:32768
    ds_read_b64_tr_b16 a[146:147], v13 offset:33280
    ds_read_b64_tr_b16 a[20:21], v13 offset:4096
    ds_read_b64_tr_b16 a[22:23], v13 offset:4608
    ds_read_b64_tr_b16 a[84:85], v13 offset:20480
    ds_read_b64_tr_b16 a[86:87], v13 offset:20992
    ds_read_b64_tr_b16 a[148:149], v13 offset:36864
    ds_read_b64_tr_b16 a[150:151], v13 offset:37376
    ds_read_b64_tr_b16 a[24:25], v13 offset:8192
    ds_read_b64_tr_b16 a[26:27], v13 offset:8704
    ds_read_b64_tr_b16 a[88:89], v13 offset:24576
    ds_read_b64_tr_b16 a[90:91], v13 offset:25088
    ds_read_b64_tr_b16 a[152:153], v13 offset:40960
    ds_read_b64_tr_b16 a[154:155], v13 offset:41472
    buffer_load_dwordx4 v5, s[12:15], s83 offen offset:2048 lds
    buffer_load_dwordx4 v6, s[12:15], s83 offen offset:3072 lds
    ds_read_b64_tr_b16 a[28:29], v13 offset:12288
    ds_read_b64_tr_b16 a[30:31], v13 offset:12800
    ds_read_b64_tr_b16 a[92:93], v13 offset:28672
    ds_read_b64_tr_b16 a[94:95], v13 offset:29184
    ds_read_b64_tr_b16 a[156:157], v13 offset:45056
    ds_read_b64_tr_b16 a[158:159], v13 offset:45568
    s_waitcnt lgkmcnt(15)
    v_pk_fma_f32 v[16:17], v[16:17], v[176:177], v[184:185]
    v_pk_fma_f32 v[18:19], v[18:19], v[178:179], v[186:187]
    v_pk_fma_f32 v[20:21], v[20:21], v[180:181], v[188:189]
    v_pk_fma_f32 v[22:23], v[22:23], v[182:183], v[190:191]
    v_cvt_pk_bf16_f32 v16, v16, v17
    v_cvt_pk_bf16_f32 v17, v18, v19
    v_cvt_pk_bf16_f32 v18, v20, v21
    v_cvt_pk_bf16_f32 v19, v22, v23
    v_pk_fma_f32 v[48:49], v[48:49], v[176:177], v[184:185]
    v_pk_fma_f32 v[50:51], v[50:51], v[178:179], v[186:187]
    v_pk_fma_f32 v[52:53], v[52:53], v[180:181], v[188:189]
    v_pk_fma_f32 v[54:55], v[54:55], v[182:183], v[190:191]
    v_cvt_pk_bf16_f32 v48, v48, v49
    s_add_u32 s83, s83, 1024
    s_add_u32 m0, s84, 16384
    s_nop 0
    buffer_load_dwordx4 v3, s[12:15], s83 offen offset:0 lds
    buffer_load_dwordx4 v4, s[12:15], s83 offen offset:1024 lds
    v_cvt_pk_bf16_f32 v49, v50, v51
    v_cvt_pk_bf16_f32 v50, v52, v53
    v_cvt_pk_bf16_f32 v51, v54, v55
    v_pk_fma_f32 v[80:81], v[80:81], v[176:177], v[184:185]
    v_pk_fma_f32 v[82:83], v[82:83], v[178:179], v[186:187]
    v_pk_fma_f32 v[84:85], v[84:85], v[180:181], v[188:189]
    v_pk_fma_f32 v[86:87], v[86:87], v[182:183], v[190:191]
    v_cvt_pk_bf16_f32 v80, v80, v81
    v_cvt_pk_bf16_f32 v81, v82, v83
    v_cvt_pk_bf16_f32 v82, v84, v85
    v_cvt_pk_bf16_f32 v83, v86, v87
    v_pk_fma_f32 v[112:113], v[112:113], v[176:177], v[184:185]
    v_pk_fma_f32 v[114:115], v[114:115], v[178:179], v[186:187]
    v_pk_fma_f32 v[116:117], v[116:117], v[180:181], v[188:189]
    v_pk_fma_f32 v[118:119], v[118:119], v[182:183], v[190:191]
    v_cvt_pk_bf16_f32 v112, v112, v113
    v_cvt_pk_bf16_f32 v113, v114, v115
    v_cvt_pk_bf16_f32 v114, v116, v117
    v_cvt_pk_bf16_f32 v115, v118, v119
    buffer_load_dwordx4 v5, s[12:15], s83 offen offset:2048 lds
    buffer_load_dwordx4 v6, s[12:15], s83 offen offset:3072 lds
    v_pk_fma_f32 v[144:145], v[144:145], v[176:177], v[184:185]
    v_pk_fma_f32 v[146:147], v[146:147], v[178:179], v[186:187]
    v_pk_fma_f32 v[148:149], v[148:149], v[180:181], v[188:189]
    v_pk_fma_f32 v[150:151], v[150:151], v[182:183], v[190:191]
    v_cvt_pk_bf16_f32 v144, v144, v145
    v_cvt_pk_bf16_f32 v145, v146, v147
    v_cvt_pk_bf16_f32 v146, v148, v149
    v_cvt_pk_bf16_f32 v147, v150, v151
    ds_read_b128 v[176:179], v10 offset:3072
    ds_read_b128 v[184:187], v10 offset:1024
    ds_read_b128 v[180:183], v10 offset:3328
    ds_read_b128 v[188:191], v10 offset:1280
    v_pk_fma_f32 v[24:25], v[24:25], v[192:193], v[200:201]
    v_pk_fma_f32 v[26:27], v[26:27], v[194:195], v[202:203]
    v_pk_fma_f32 v[28:29], v[28:29], v[196:197], v[204:205]
    v_pk_fma_f32 v[30:31], v[30:31], v[198:199], v[206:207]
    v_cvt_pk_bf16_f32 v24, v24, v25
    v_cvt_pk_bf16_f32 v25, v26, v27
    s_add_u32 s83, s83, 1024
    s_add_u32 m0, s84, 32768
    s_nop 0
    buffer_load_dwordx4 v3, s[12:15], s83 offen offset:0 lds
    buffer_load_dwordx4 v4, s[12:15], s83 offen offset:1024 lds
    v_cvt_pk_bf16_f32 v26, v28, v29
    v_cvt_pk_bf16_f32 v27, v30, v31
    v_pk_fma_f32 v[56:57], v[56:57], v[192:193], v[200:201]
    v_pk_fma_f32 v[58:59], v[58:59], v[194:195], v[202:203]
    v_pk_fma_f32 v[60:61], v[60:61], v[196:197], v[204:205]
    v_pk_fma_f32 v[62:63], v[62:63], v[198:199], v[206:207]
    v_cvt_pk_bf16_f32 v56, v56, v57
    v_cvt_pk_bf16_f32 v57, v58, v59
    v_cvt_pk_bf16_f32 v58, v60, v61
    v_cvt_pk_bf16_f32 v59, v62, v63
    v_pk_fma_f32 v[88:89], v[88:89], v[192:193], v[200:201]
    v_pk_fma_f32 v[90:91], v[90:91], v[194:195], v[202:203]
    v_pk_fma_f32 v[92:93], v[92:93], v[196:197], v[204:205]
    v_pk_fma_f32 v[94:95], v[94:95], v[198:199], v[206:207]
    v_cvt_pk_bf16_f32 v88, v88, v89
    v_cvt_pk_bf16_f32 v89, v90, v91
    v_cvt_pk_bf16_f32 v90, v92, v93
    v_cvt_pk_bf16_f32 v91, v94, v95
    v_pk_fma_f32 v[120:121], v[120:121], v[192:193], v[200:201]
    buffer_load_dwordx4 v5, s[12:15], s83 offen offset:2048 lds
    buffer_load_dwordx4 v6, s[12:15], s83 offen offset:3072 lds
    v_pk_fma_f32 v[122:123], v[122:123], v[194:195], v[202:203]
    v_pk_fma_f32 v[124:125], v[124:125], v[196:197], v[204:205]
    v_pk_fma_f32 v[126:127], v[126:127], v[198:199], v[206:207]
    v_cvt_pk_bf16_f32 v120, v120, v121
    v_cvt_pk_bf16_f32 v121, v122, v123
    v_cvt_pk_bf16_f32 v122, v124, v125
    v_cvt_pk_bf16_f32 v123, v126, v127
    v_pk_fma_f32 v[152:153], v[152:153], v[192:193], v[200:201]
    v_pk_fma_f32 v[154:155], v[154:155], v[194:195], v[202:203]
    v_pk_fma_f32 v[156:157], v[156:157], v[196:197], v[204:205]
    v_pk_fma_f32 v[158:159], v[158:159], v[198:199], v[206:207]
    v_cvt_pk_bf16_f32 v152, v152, v153
    v_cvt_pk_bf16_f32 v153, v154, v155
    v_cvt_pk_bf16_f32 v154, v156, v157
    v_cvt_pk_bf16_f32 v155, v158, v159
    ds_read_b128 v[192:195], v10 offset:3584
    ds_read_b128 v[200:203], v10 offset:1536
    ds_read_b128 v[196:199], v10 offset:3840
    ds_read_b128 v[204:207], v10 offset:1792
    v_subrev_u32 v9, 16384, v216
    v_subrev_u32 v11, 16384, v217
    v_subrev_u32 v3, 16384, v218
    v_subrev_u32 v4, 16384, v219
    s_lshl_b32 s94, s101, 7
    buffer_load_dwordx4 v[208:211], v15, s[28:31], s94 offen
    s_add_u32 s94, s94, 6144
    buffer_load_dwordx4 v[212:215], v15, s[28:31], s94 offen
    s_add_u32 s94, s94, 6144
    buffer_load_dwordx4 v[240:243], v15, s[28:31], s94 offen
    s_add_u32 s94, s94, 6144
    buffer_load_dwordx4 v[244:247], v15, s[28:31], s94 offen
    s_waitcnt vmcnt(16)
    s_waitcnt lgkmcnt(0)
    s_barrier
    ds_read_b64_tr_b16 a[32:33], v14 offset:0
    ds_read_b64_tr_b16 a[34:35], v14 offset:512
    ds_read_b64_tr_b16 a[96:97], v14 offset:16384
    ds_read_b64_tr_b16 a[98:99], v14 offset:16896
    ds_read_b64_tr_b16 a[160:161], v14 offset:32768
    ds_read_b64_tr_b16 a[162:163], v14 offset:33280
    ds_read_b64_tr_b16 a[36:37], v14 offset:4096
    ds_read_b64_tr_b16 a[38:39], v14 offset:4608
    ds_read_b64_tr_b16 a[100:101], v14 offset:20480
    ds_read_b64_tr_b16 a[102:103], v14 offset:20992
    ds_read_b64_tr_b16 a[164:165], v14 offset:36864
    ds_read_b64_tr_b16 a[166:167], v14 offset:37376
    ds_read_b64_tr_b16 a[40:41], v14 offset:8192
    ds_read_b64_tr_b16 a[42:43], v14 offset:8704
    ds_read_b64_tr_b16 a[104:105], v14 offset:24576
    ds_read_b64_tr_b16 a[106:107], v14 offset:25088
    ds_read_b64_tr_b16 a[168:169], v14 offset:40960
    ds_read_b64_tr_b16 a[170:171], v14 offset:41472
    ds_read_b64_tr_b16 a[44:45], v14 offset:12288
    ds_read_b64_tr_b16 a[46:47], v14 offset:12800
    ds_read_b64_tr_b16 a[108:109], v14 offset:28672
    ds_read_b64_tr_b16 a[110:111], v14 offset:29184
    ds_read_b64_tr_b16 a[172:173], v14 offset:45056
    ds_read_b64_tr_b16 a[174:175], v14 offset:45568
    v_pk_fma_f32 v[32:33], v[32:33], v[176:177], v[184:185]
    v_pk_fma_f32 v[34:35], v[34:35], v[178:179], v[186:187]
    v_pk_fma_f32 v[36:37], v[36:37], v[180:181], v[188:189]
    v_pk_fma_f32 v[38:39], v[38:39], v[182:183], v[190:191]
    ds_write_b128 v9, v[16:19]
    v_cvt_pk_bf16_f32 v32, v32, v33
    v_cvt_pk_bf16_f32 v33, v34, v35
    v_cvt_pk_bf16_f32 v34, v36, v37
    v_cvt_pk_bf16_f32 v35, v38, v39
    v_pk_fma_f32 v[64:65], v[64:65], v[176:177], v[184:185]
    v_pk_fma_f32 v[66:67], v[66:67], v[178:179], v[186:187]
    v_pk_fma_f32 v[68:69], v[68:69], v[180:181], v[188:189]
    v_pk_fma_f32 v[70:71], v[70:71], v[182:183], v[190:191]
    v_cvt_pk_bf16_f32 v64, v64, v65
    ds_write_b128 v216, v[48:51] offset:0
    v_cvt_pk_bf16_f32 v65, v66, v67
    v_cvt_pk_bf16_f32 v66, v68, v69
    v_cvt_pk_bf16_f32 v67, v70, v71
    v_pk_fma_f32 v[96:97], v[96:97], v[176:177], v[184:185]
    v_pk_fma_f32 v[98:99], v[98:99], v[178:179], v[186:187]
    v_pk_fma_f32 v[100:101], v[100:101], v[180:181], v[188:189]
    v_pk_fma_f32 v[102:103], v[102:103], v[182:183], v[190:191]
    v_cvt_pk_bf16_f32 v96, v96, v97
    v_cvt_pk_bf16_f32 v97, v98, v99
    ds_write_b128 v11, v[24:27]
    v_cvt_pk_bf16_f32 v98, v100, v101
    v_cvt_pk_bf16_f32 v99, v102, v103
    v_pk_fma_f32 v[128:129], v[128:129], v[176:177], v[184:185]
    v_pk_fma_f32 v[130:131], v[130:131], v[178:179], v[186:187]
    v_pk_fma_f32 v[132:133], v[132:133], v[180:181], v[188:189]
    v_pk_fma_f32 v[134:135], v[134:135], v[182:183], v[190:191]
    v_cvt_pk_bf16_f32 v128, v128, v129
    v_cvt_pk_bf16_f32 v129, v130, v131
    v_cvt_pk_bf16_f32 v130, v132, v133
    ds_write_b128 v217, v[56:59] offset:0
    v_cvt_pk_bf16_f32 v131, v134, v135
    v_pk_fma_f32 v[160:161], v[160:161], v[176:177], v[184:185]
    v_pk_fma_f32 v[162:163], v[162:163], v[178:179], v[186:187]
    v_pk_fma_f32 v[164:165], v[164:165], v[180:181], v[188:189]
    v_pk_fma_f32 v[166:167], v[166:167], v[182:183], v[190:191]
    v_cvt_pk_bf16_f32 v160, v160, v161
    v_cvt_pk_bf16_f32 v161, v162, v163
    v_cvt_pk_bf16_f32 v162, v164, v165
    v_cvt_pk_bf16_f32 v163, v166, v167
    s_lshl_b32 s96, s2, 2
    s_add_u32 s96, s96, s5
    s_lshl_b32 s95, s96, 9
    v_and_b32 v5, 3, v0
    v_lshl_add_u32 v5, v5, 7, s95
    s_mul_i32 s95, s96, 1792
    v_min_u32 v6, 13, v0
    v_lshl_add_u32 v6, v6, 7, s95
    s_lshr_b32 s94, s16, 7
    s_sub_u32 s94, 3, s94
    s_and_b32 s94, s94, 7
    s_lshl_b32 s94, s94, 7
    s_lshl_b32 s97, s4, 2
    s_add_u32 s97, s97, s5
    s_mul_i32 s97, s97, 4096
    s_add_u32 s94, s94, s97
    v_and_b32 v14, 31, v0
    v_min_u32 v14, 3, v14
    v_lshl_add_u32 v14, v14, 10, s94
    v_cmp_lt_u32 vcc, 31, v0
    s_nop 1
    v_cndmask_b32 v5, v5, v14, vcc
    buffer_load_dword v255, v5, s[16:19], 0 offen
    buffer_load_dword v255, v6, s[20:23], 0 offen
    v_pk_fma_f32 v[40:41], v[40:41], v[192:193], v[200:201]
    v_pk_fma_f32 v[42:43], v[42:43], v[194:195], v[202:203]
    v_pk_fma_f32 v[44:45], v[44:45], v[196:197], v[204:205]
    v_pk_fma_f32 v[46:47], v[46:47], v[198:199], v[206:207]
    ds_write_b128 v3, v[32:35]
    v_cvt_pk_bf16_f32 v40, v40, v41
    v_cvt_pk_bf16_f32 v41, v42, v43
    v_cvt_pk_bf16_f32 v42, v44, v45
    v_cvt_pk_bf16_f32 v43, v46, v47
    v_pk_fma_f32 v[72:73], v[72:73], v[192:193], v[200:201]
    v_pk_fma_f32 v[74:75], v[74:75], v[194:195], v[202:203]
    ds_write_b128 v218, v[64:67] offset:0
    v_pk_fma_f32 v[76:77], v[76:77], v[196:197], v[204:205]
    v_pk_fma_f32 v[78:79], v[78:79], v[198:199], v[206:207]
    v_cvt_pk_bf16_f32 v72, v72, v73
    v_cvt_pk_bf16_f32 v73, v74, v75
    v_cvt_pk_bf16_f32 v74, v76, v77
    v_cvt_pk_bf16_f32 v75, v78, v79
    v_pk_fma_f32 v[104:105], v[104:105], v[192:193], v[200:201]
    v_pk_fma_f32 v[106:107], v[106:107], v[194:195], v[202:203]
    v_pk_fma_f32 v[108:109], v[108:109], v[196:197], v[204:205]
    v_pk_fma_f32 v[110:111], v[110:111], v[198:199], v[206:207]
    ds_write_b128 v4, v[40:43]
    v_cvt_pk_bf16_f32 v104, v104, v105
    v_cvt_pk_bf16_f32 v105, v106, v107
    v_cvt_pk_bf16_f32 v106, v108, v109
    v_cvt_pk_bf16_f32 v107, v110, v111
    v_pk_fma_f32 v[136:137], v[136:137], v[192:193], v[200:201]
    v_pk_fma_f32 v[138:139], v[138:139], v[194:195], v[202:203]
    v_pk_fma_f32 v[140:141], v[140:141], v[196:197], v[204:205]
    v_pk_fma_f32 v[142:143], v[142:143], v[198:199], v[206:207]
    v_cvt_pk_bf16_f32 v136, v136, v137
    v_cvt_pk_bf16_f32 v137, v138, v139
    ds_write_b128 v219, v[72:75] offset:0
    v_cvt_pk_bf16_f32 v138, v140, v141
    v_cvt_pk_bf16_f32 v139, v142, v143
    v_pk_fma_f32 v[168:169], v[168:169], v[192:193], v[200:201]
    v_pk_fma_f32 v[170:171], v[170:171], v[194:195], v[202:203]
    v_pk_fma_f32 v[172:173], v[172:173], v[196:197], v[204:205]
    v_pk_fma_f32 v[174:175], v[174:175], v[198:199], v[206:207]
    v_cvt_pk_bf16_f32 v168, v168, v169
    v_cvt_pk_bf16_f32 v169, v170, v171
    v_cvt_pk_bf16_f32 v170, v172, v173
    v_cvt_pk_bf16_f32 v171, v174, v175
    s_waitcnt lgkmcnt(0)
    s_barrier
    ds_read_b128 v[16:19], v220 offset:0
    ds_read_b128 v[20:23], v221 offset:0
    ds_read_b128 v[24:27], v222 offset:0
    ds_read_b128 v[28:31], v223 offset:0
    ds_read_b128 v[32:35], v220 offset:256
    ds_read_b128 v[36:39], v221 offset:256
    s_waitcnt lgkmcnt(4)
    ds_read_b128 v[40:43], v222 offset:256
    v_mfma_f32_16x16x32_bf16 v[52:55], a[64:67], v[16:19], 0
    v_mfma_f32_16x16x32_bf16 v[56:59], v[16:19], a[128:131], 0
    s_lshl_b32 s92, s4, 2
    ds_read_b128 v[44:47], v223 offset:256
    s_add_u32 s92, s92, s5
    s_lshl_b32 s93, s92, 14
    s_lshl_b32 s94, s3, 7
    s_add_u32 s93, s93, s94
    v_mfma_f32_16x16x32_bf16 v[52:55], a[68:71], v[20:23], v[52:55]
    s_lshl_b32 s94, s5, 11
    s_add_u32 m0, s94, 147456
    s_cmp_lt_u32 s4, 28
    s_cselect_b32 s93, s93, 0
    buffer_load_dwordx4 v238, s[24:27], s93 offen lds
    v_mfma_f32_16x16x32_bf16 v[56:59], v[20:23], a[132:135], v[56:59]
    s_waitcnt lgkmcnt(4)
    ds_read_b128 v[16:19], v220 offset:512
    buffer_load_dwordx4 v239, s[24:27], s93 offen offset:1024 lds
    v_and_b32 v9, 7, v0
    v_mfma_f32_16x16x32_bf16 v[52:55], a[72:75], v[24:27], v[52:55]
    ds_write_b128 v216, v[80:83] offset:16384
    v_mfma_f32_16x16x32_bf16 v[56:59], v[24:27], a[136:139], v[56:59]
    ds_read_b128 v[20:23], v221 offset:512
    v_lshlrev_b32 v9, 2, v9
    v_lshrrev_b32 v10, 4, v0
    v_mfma_f32_16x16x32_bf16 v[52:55], a[76:79], v[28:31], v[52:55]
    ds_write_b128 v217, v[88:91] offset:16384
    v_mfma_f32_16x16x32_bf16 v[56:59], v[28:31], a[140:143], v[56:59]
    s_waitcnt lgkmcnt(6)
    ds_read_b128 v[24:27], v222 offset:512
    v_add_u32 v9, v9, v10
    s_lshl_b32 s96, s5, 8
    s_add_u32 s96, s96, 155648
    v_mfma_f32_16x16x32_bf16 v[52:55], a[80:83], v[32:35], v[52:55]
    ds_write_b128 v218, v[96:99] offset:16384
    v_mfma_f32_16x16x32_bf16 v[56:59], v[32:35], a[144:147], v[56:59]
    ds_read_b128 v[28:31], v223 offset:512
    v_lshl_add_u32 v9, v9, 3, s96
    s_sub_u32 s96, s4, 8
    v_mfma_f32_16x16x32_bf16 v[52:55], a[84:87], v[36:39], v[52:55]
    ds_write_b128 v219, v[104:107] offset:16384
    v_mfma_f32_16x16x32_bf16 v[56:59], v[36:39], a[148:151], v[56:59]
    s_waitcnt lgkmcnt(8)
    ds_read_b128 v[32:35], v220 offset:16384
    s_cmp_lt_u32 s96, 16
    s_cselect_b32 s96, 16, 0
    s_cmp_eq_u32 s5, 0
    v_mfma_f32_16x16x32_bf16 v[52:55], a[88:91], v[40:43], v[52:55]
    ds_write_b128 v216, v[112:115] offset:32768
    v_mfma_f32_16x16x32_bf16 v[56:59], v[40:43], a[152:155], v[56:59]
    s_cselect_b32 s96, s96, 0
    ds_read_b128 v[36:39], v221 offset:16384
    v_and_b32 v10, 15, v0
    v_mfma_f32_16x16x32_bf16 v[52:55], a[92:95], v[44:47], v[52:55]
    ds_write_b128 v217, v[120:123] offset:32768
    v_mfma_f32_16x16x32_bf16 v[56:59], v[44:47], a[156:159], v[56:59]
    s_waitcnt lgkmcnt(9)
    ds_read_b128 v[40:43], v222 offset:16384
    v_lshlrev_b32 v10, 4, v10
    v_add_u32 v11, 155648, v10
    v_cmp_gt_u32 vcc, s96, v0
    v_mfma_f32_16x16x32_bf16 v[52:55], a[96:99], v[16:19], v[52:55]
    ds_write_b128 v218, v[128:131] offset:32768
    v_mfma_f32_16x16x32_bf16 v[56:59], v[16:19], a[160:163], v[56:59]
    ds_read_b128 v[44:47], v223 offset:16384
    v_cndmask_b32_e64 v14, 1, 0, vcc
    v_lshl_or_b32 v10, v14, 28, v10
    v_and_b32 v5, 15, v0
    v_mfma_f32_16x16x32_bf16 v[52:55], a[100:103], v[20:23], v[52:55]
    ds_write_b128 v219, v[136:139] offset:32768
    v_mfma_f32_16x16x32_bf16 v[56:59], v[20:23], a[164:167], v[56:59]
    s_waitcnt lgkmcnt(9)
    ds_read_b128 v[16:19], v220 offset:16640
    v_lshlrev_b32 v5, 11, v5
    v_lshrrev_b32 v6, 4, v0
    v_mfma_f32_16x16x32_bf16 v[52:55], a[104:107], v[24:27], v[52:55]
    ds_write_b128 v216, v[144:147] offset:49152
    v_mfma_f32_16x16x32_bf16 v[56:59], v[24:27], a[168:171], v[56:59]
    ds_read_b128 v[20:23], v221 offset:16640
    v_lshl_add_u32 v7, v6, 4, v5
    s_lshr_b32 s95, s5, 1
    s_lshl_b32 s95, s95, 5
    v_mfma_f32_16x16x32_bf16 v[52:55], a[108:111], v[28:31], v[52:55]
    ds_write_b128 v217, v[152:155] offset:49152
    v_mfma_f32_16x16x32_bf16 v[56:59], v[28:31], a[172:175], v[56:59]
    s_waitcnt lgkmcnt(9)
    ds_read_b128 v[24:27], v222 offset:16640
    s_and_b32 s96, s5, 1
    s_add_u32 s95, s95, s96
    v_mfma_f32_16x16x32_bf16 v[60:63], a[0:3], v[32:35], 0
    ds_write_b128 v218, v[160:163] offset:49152
    v_mfma_f32_16x16x32_bf16 v[64:67], a[64:67], v[32:35], 0
    s_lshl_b32 s96, s88, 6
    s_add_u32 s95, s95, s96
    s_lshl_b32 s95, s95, 10
    v_mfma_f32_16x16x32_bf16 v[68:71], v[32:35], a[128:131], 0
    ds_read_b128 v[28:31], v223 offset:16640
    v_mfma_f32_16x16x32_bf16 v[60:63], a[4:7], v[36:39], v[60:63]
    ds_write_b128 v219, v[168:171] offset:49152
    v_mfma_f32_16x16x32_bf16 v[64:67], a[68:71], v[36:39], v[64:67]
    s_lshl_b32 s96, s89, 7
    s_add_u32 s87, s95, s96
    s_lshl_b32 s93, s4, 2
    s_add_u32 s93, s93, s5
    s_mul_i32 s93, s93, 3584
    v_mfma_f32_16x16x32_bf16 v[68:71], v[36:39], a[132:135], v[68:71]
    s_waitcnt lgkmcnt(9)
    ds_read_b128 v[32:35], v220 offset:16896
    v_min_u32 v3, 27, v0
    v_lshl_add_u32 v3, v3, 7, s93
    s_mov_b32 s93, 458752
    v_mfma_f32_16x16x32_bf16 v[60:63], a[8:11], v[40:43], v[60:63]
    buffer_load_dword v255, v3, s[20:23], s93 offen
    v_mfma_f32_16x16x32_bf16 v[64:67], a[72:75], v[40:43], v[64:67]
    v_mfma_f32_16x16x32_bf16 v[68:71], v[40:43], a[136:139], v[68:71]
    ds_read_b128 v[36:39], v221 offset:16896
    v_mfma_f32_16x16x32_bf16 v[60:63], a[12:15], v[44:47], v[60:63]
    v_mfma_f32_16x16x32_bf16 v[64:67], a[76:79], v[44:47], v[64:67]
    v_mfma_f32_16x16x32_bf16 v[68:71], v[44:47], a[140:143], v[68:71]
    s_waitcnt lgkmcnt(7)
    ds_read_b128 v[40:43], v222 offset:16896
    v_mfma_f32_16x16x32_bf16 v[60:63], a[16:19], v[16:19], v[60:63]
    v_mfma_f32_16x16x32_bf16 v[64:67], a[80:83], v[16:19], v[64:67]
    v_mfma_f32_16x16x32_bf16 v[68:71], v[16:19], a[144:147], v[68:71]
    ds_read_b128 v[44:47], v223 offset:16896
    v_mfma_f32_16x16x32_bf16 v[60:63], a[20:23], v[20:23], v[60:63]
    v_mfma_f32_16x16x32_bf16 v[64:67], a[84:87], v[20:23], v[64:67]
    v_mfma_f32_16x16x32_bf16 v[68:71], v[20:23], a[148:151], v[68:71]
    s_waitcnt vmcnt(9)
    s_waitcnt lgkmcnt(0)
    s_barrier
    ds_read_b128 v[16:19], v220 offset:768
    v_mfma_f32_16x16x32_bf16 v[60:63], a[24:27], v[24:27], v[60:63]
    ds_read_b64_tr_b16 a[48:49], v12 offset:0
    ds_read_b64_tr_b16 a[50:51], v12 offset:512
    v_mfma_f32_16x16x32_bf16 v[64:67], a[88:91], v[24:27], v[64:67]
    ds_read_b64_tr_b16 a[112:113], v12 offset:16384
    ds_read_b64_tr_b16 a[114:115], v12 offset:16896
    v_mfma_f32_16x16x32_bf16 v[68:71], v[24:27], a[152:155], v[68:71]
    ds_read_b128 v[20:23], v221 offset:768
    ds_read_b64_tr_b16 a[176:177], v12 offset:32768
    v_mfma_f32_16x16x32_bf16 v[60:63], a[28:31], v[28:31], v[60:63]
    ds_read_b64_tr_b16 a[178:179], v12 offset:33280
    ds_read_b64_tr_b16 a[52:53], v12 offset:4096
    v_mfma_f32_16x16x32_bf16 v[64:67], a[92:95], v[28:31], v[64:67]
    ds_read_b64_tr_b16 a[54:55], v12 offset:4608
    ds_read_b64_tr_b16 a[116:117], v12 offset:20480
    v_mfma_f32_16x16x32_bf16 v[68:71], v[28:31], a[156:159], v[68:71]
    ds_read_b128 v[24:27], v222 offset:768
    ds_read_b64_tr_b16 a[118:119], v12 offset:20992
    v_mfma_f32_16x16x32_bf16 v[60:63], a[32:35], v[32:35], v[60:63]
    ds_read_b64_tr_b16 a[180:181], v12 offset:36864
    ds_read_b64_tr_b16 a[182:183], v12 offset:37376
    v_mfma_f32_16x16x32_bf16 v[64:67], a[96:99], v[32:35], v[64:67]
    ds_read_b64_tr_b16 a[56:57], v12 offset:8192
    ds_read_b64_tr_b16 a[58:59], v12 offset:8704
    v_mfma_f32_16x16x32_bf16 v[68:71], v[32:35], a[160:163], v[68:71]
    ds_read_b128 v[28:31], v223 offset:768
    ds_read_b64_tr_b16 a[120:121], v12 offset:24576
    v_mfma_f32_16x16x32_bf16 v[60:63], a[36:39], v[36:39], v[60:63]
    ds_read_b64_tr_b16 a[122:123], v12 offset:25088
    ds_read_b64_tr_b16 a[184:185], v12 offset:40960
    v_mfma_f32_16x16x32_bf16 v[64:67], a[100:103], v[36:39], v[64:67]
    ds_read_b64_tr_b16 a[186:187], v12 offset:41472
    ds_read_b64_tr_b16 a[60:61], v12 offset:12288
    v_mfma_f32_16x16x32_bf16 v[68:71], v[36:39], a[164:167], v[68:71]
    ds_read_b128 v[32:35], v220 offset:17152
    ds_read_b64_tr_b16 a[62:63], v12 offset:12800
    v_mfma_f32_16x16x32_bf16 v[60:63], a[40:43], v[40:43], v[60:63]
    ds_read_b64_tr_b16 a[124:125], v12 offset:28672
    ds_read_b64_tr_b16 a[126:127], v12 offset:29184
    v_mfma_f32_16x16x32_bf16 v[64:67], a[104:107], v[40:43], v[64:67]
    ds_read_b64_tr_b16 a[188:189], v12 offset:45056
    ds_read_b64_tr_b16 a[190:191], v12 offset:45568
    v_mfma_f32_16x16x32_bf16 v[68:71], v[40:43], a[168:171], v[68:71]
    ds_read_b128 v[36:39], v221 offset:17152
    v_mfma_f32_16x16x32_bf16 v[60:63], a[44:47], v[44:47], v[60:63]
    v_mfma_f32_16x16x32_bf16 v[64:67], a[108:111], v[44:47], v[64:67]
    v_mfma_f32_16x16x32_bf16 v[68:71], v[44:47], a[172:175], v[68:71]
    s_waitcnt lgkmcnt(15)
    ds_read_b128 v[40:43], v222 offset:17152
    v_mfma_f32_16x16x32_bf16 v[52:55], a[112:115], v[16:19], v[52:55]
    s_lshl_b32 s93, s4, 2
    s_add_u32 s93, s93, s5
    s_mul_i32 s93, s93, 3584
    v_mfma_f32_16x16x32_bf16 v[56:59], v[16:19], a[176:179], v[56:59]
    ds_read_b128 v[44:47], v223 offset:17152
    v_min_u32 v3, 27, v0
    v_mfma_f32_16x16x32_bf16 v[52:55], a[116:119], v[20:23], v[52:55]
    v_lshl_add_u32 v3, v3, 7, s93
    s_mov_b32 s93, 917504
    v_mfma_f32_16x16x32_bf16 v[56:59], v[20:23], a[180:183], v[56:59]
    s_waitcnt lgkmcnt(14)
    ds_read_b128 v[16:19], v220 offset:32768
    buffer_load_dword v255, v3, s[20:23], s93 offen
    s_waitcnt lgkmcnt(13)
    v_mfma_f32_16x16x32_bf16 v[52:55], a[120:123], v[24:27], v[52:55]
    s_lshl_b32 s93, s88, 7
    s_add_u32 s93, s93, 32768
    v_min_u32 v3, 2, v0
    s_waitcnt lgkmcnt(11)
    v_mfma_f32_16x16x32_bf16 v[56:59], v[24:27], a[184:187], v[56:59]
    ds_read_b128 v[20:23], v221 offset:32768
    v_lshlrev_b32 v3, 12, v3
    s_waitcnt lgkmcnt(7)
    v_mfma_f32_16x16x32_bf16 v[52:55], a[124:127], v[28:31], v[52:55]
    buffer_load_dword v255, v3, s[36:39], s93 offen
    v_mov_b32 v136, 0x3f803f80
    s_waitcnt lgkmcnt(5)
    v_mfma_f32_16x16x32_bf16 v[56:59], v[28:31], a[188:191], v[56:59]
    s_waitcnt lgkmcnt(4)
    ds_read_b128 v[24:27], v222 offset:32768
    v_mov_b32 v137, 0x3f803f80
    v_mfma_f32_16x16x32_bf16 v[60:63], a[48:51], v[32:35], v[60:63]
    v_mov_b32 v138, 0x3f803f80
    v_mov_b32 v139, 0x3f803f80
    v_mfma_f32_16x16x32_bf16 v[64:67], a[112:115], v[32:35], v[64:67]
    v_mov_b32 v140, 0xf149f2ca
    s_mov_b32 s96, 0x05040100
    v_mfma_f32_16x16x32_bf16 v[68:71], v[32:35], a[176:179], v[68:71]
    s_mov_b32 s97, 0x07060302
    ds_read_b128 v[28:31], v223 offset:32768
    s_waitcnt vmcnt(9)
    v_perm_b32 v192, v212, v208, s96
    v_mfma_f32_16x16x32_bf16 v[60:63], a[52:55], v[36:39], v[60:63]
    v_perm_b32 v193, v212, v208, s97
    v_perm_b32 v194, v213, v209, s96
    v_mfma_f32_16x16x32_bf16 v[64:67], a[116:119], v[36:39], v[64:67]
    v_perm_b32 v195, v213, v209, s97
    v_perm_b32 v196, v214, v210, s96
    v_mfma_f32_16x16x32_bf16 v[68:71], v[36:39], a[180:183], v[68:71]
    s_waitcnt lgkmcnt(4)
    ds_read_b128 v[32:35], v220 offset:33024
    v_perm_b32 v197, v214, v210, s97
    v_mfma_f32_16x16x32_bf16 v[60:63], a[56:59], v[40:43], v[60:63]
    v_perm_b32 v198, v215, v211, s96
    v_perm_b32 v199, v215, v211, s97
    v_mfma_f32_16x16x32_bf16 v[64:67], a[120:123], v[40:43], v[64:67]
    v_dot2_f32_bf16 v208, v192, v250, 0
    v_dot2_f32_bf16 v209, v193, v250, 0
    v_mfma_f32_16x16x32_bf16 v[68:71], v[40:43], a[184:187], v[68:71]
    ds_read_b128 v[36:39], v221 offset:33024
    v_dot2_f32_bf16 v210, v194, v250, 0
    v_mfma_f32_16x16x32_bf16 v[60:63], a[60:63], v[44:47], v[60:63]
    v_dot2_f32_bf16 v211, v195, v250, 0
    v_dot2_f32_bf16 v212, v196, v250, 0
    v_mfma_f32_16x16x32_bf16 v[64:67], a[124:127], v[44:47], v[64:67]
    v_dot2_f32_bf16 v213, v197, v250, 0
    v_dot2_f32_bf16 v214, v198, v250, 0
    v_mfma_f32_16x16x32_bf16 v[68:71], v[44:47], a[188:191], v[68:71]
    v_dot2_f32_bf16 v215, v199, v250, 0
    s_waitcnt vmcnt(7)
    v_perm_b32 v200, v244, v240, s96
    v_perm_b32 v201, v244, v240, s97
    v_perm_b32 v202, v245, v241, s96
    v_perm_b32 v203, v245, v241, s97
    v_perm_b32 v204, v246, v242, s96
    v_perm_b32 v205, v246, v242, s97
    v_perm_b32 v206, v247, v243, s96
    v_perm_b32 v207, v247, v243, s97
    v_dot2_f32_bf16 v208, v200, v251, v208
    v_dot2_f32_bf16 v209, v201, v251, v209
    v_dot2_f32_bf16 v210, v202, v251, v210
    v_dot2_f32_bf16 v211, v203, v251, v211
    v_dot2_f32_bf16 v212, v204, v251, v212
    v_dot2_f32_bf16 v213, v205, v251, v213
    v_dot2_f32_bf16 v214, v206, v251, v214
    v_dot2_f32_bf16 v215, v207, v251, v215
    v_permlane32_swap_b32 v208, v212
    v_permlane32_swap_b32 v209, v213
    v_permlane32_swap_b32 v210, v214
    v_permlane32_swap_b32 v211, v215
    v_add_f32 v208, v208, v212
    v_add_f32 v209, v209, v213
    v_add_f32 v210, v210, v214
    v_add_f32 v211, v211, v215
    s_nop 0
    v_permlane16_swap_b32 v208, v210
    v_permlane16_swap_b32 v209, v211
    v_add_f32 v208, v208, v210
    v_add_f32 v209, v209, v211
    s_nop 0
    v_add_f32_dpp v208, v208, v208 row_ror:8 row_mask:0xf bank_mask:0xf
    v_add_f32_dpp v209, v209, v209 row_ror:8 row_mask:0xf bank_mask:0xf
    ds_write_b64 v9, v[208:209]
    s_waitcnt lgkmcnt(0)
    s_barrier
    ds_read_b128 v[40:43], v222 offset:33024
    v_mfma_f32_16x16x32_bf16 v[72:75], a[0:3], v[16:19], 0
    s_lshl_b32 s86, s5, 17
    s_lshl_b32 s1, s89, 7
    s_add_u32 s86, s86, s1
    v_mfma_f32_16x16x32_bf16 v[76:79], a[64:67], v[16:19], 0
    s_mul_i32 s1, s5, 16512
    s_add_u32 m0, s1, 0
    v_mfma_f32_16x16x32_bf16 v[80:83], v[16:19], a[128:131], 0
    ds_read_b128 v[44:47], v223 offset:33024
    buffer_load_dwordx4 v232, s[16:19], s86 offen offset:0 lds
    v_mfma_f32_16x16x32_bf16 v[72:75], a[4:7], v[20:23], v[72:75]
    v_cvt_pk_bf16_f32 v116, v52, v53
    v_mfma_f32_16x16x32_bf16 v[76:79], a[68:71], v[20:23], v[76:79]
    ds_read_b128 v[192:195], v11 offset:0
    ds_read_b128 v[196:199], v11 offset:256
    v_mfma_f32_16x16x32_bf16 v[80:83], v[20:23], a[132:135], v[80:83]
    ds_read_b128 v[16:19], v220 offset:33280
    v_cvt_pk_bf16_f32 v117, v54, v55
    v_mfma_f32_16x16x32_bf16 v[72:75], a[8:11], v[24:27], v[72:75]
    ds_read_b128 v[200:203], v11 offset:512
    v_cvt_pk_bf16_f32 v130, v56, v57
    v_mfma_f32_16x16x32_bf16 v[76:79], a[72:75], v[24:27], v[76:79]
    ds_read_b128 v[204:207], v11 offset:768
    v_cvt_pk_bf16_f32 v131, v58, v59
    v_mfma_f32_16x16x32_bf16 v[80:83], v[24:27], a[136:139], v[80:83]
    ds_read_b128 v[20:23], v221 offset:33280
    s_waitcnt lgkmcnt(4)
    v_add_f32 v192, v192, v196
    v_mfma_f32_16x16x32_bf16 v[72:75], a[12:15], v[28:31], v[72:75]
    v_cvt_pk_bf16_f32 v108, v60, v61
    v_mfma_f32_16x16x32_bf16 v[76:79], a[76:79], v[28:31], v[76:79]
    buffer_load_dwordx4 v233, s[16:19], s86 offen offset:1032 lds
    v_add_f32 v193, v193, v197
    v_mfma_f32_16x16x32_bf16 v[80:83], v[28:31], a[140:143], v[80:83]
    ds_read_b128 v[24:27], v222 offset:33280
    v_cvt_pk_bf16_f32 v118, v64, v65
    v_mfma_f32_16x16x32_bf16 v[72:75], a[16:19], v[32:35], v[72:75]
    v_add_f32 v194, v194, v198
    v_cvt_pk_bf16_f32 v109, v62, v63
    v_mfma_f32_16x16x32_bf16 v[76:79], a[80:83], v[32:35], v[76:79]
    v_add_f32 v195, v195, v199
    v_cvt_pk_bf16_f32 v119, v66, v67
    v_mfma_f32_16x16x32_bf16 v[80:83], v[32:35], a[144:147], v[80:83]
    ds_read_b128 v[28:31], v223 offset:33280
    s_waitcnt lgkmcnt(3)
    v_add_f32 v200, v200, v204
    v_mfma_f32_16x16x32_bf16 v[72:75], a[20:23], v[36:39], v[72:75]
    v_add_f32 v201, v201, v205
    v_cvt_pk_bf16_f32 v128, v68, v69
    v_mfma_f32_16x16x32_bf16 v[76:79], a[84:87], v[36:39], v[76:79]
    v_add_f32 v202, v202, v206
    v_cvt_pk_bf16_f32 v129, v70, v71
    v_mfma_f32_16x16x32_bf16 v[80:83], v[36:39], a[148:151], v[80:83]
    buffer_load_dwordx4 v234, s[16:19], s86 offen offset:2064 lds
    v_add_f32 v203, v203, v207
    v_mfma_f32_16x16x16_bf16 v[144:147], v[118:119], v[108:109], 0
    ds_read_b128 v[32:35], v220 offset:33536
    v_add_f32 v192, v192, v200
    v_mfma_f32_16x16x16_bf16 v[148:151], v[116:117], v[108:109], 0
    v_mfma_f32_16x16x32_bf16 v[72:75], a[24:27], v[40:43], v[72:75]
    v_add_f32 v193, v193, v201
    v_mfma_f32_16x16x32_bf16 v[76:79], a[88:91], v[40:43], v[76:79]
    v_mfma_f32_16x16x32_bf16 v[80:83], v[40:43], a[152:155], v[80:83]
    ds_read_b128 v[36:39], v221 offset:33536
    v_cndmask_b32 v144, v140, v144, s[48:49]
    v_mfma_f32_16x16x32_bf16 v[72:75], a[28:31], v[44:47], v[72:75]
    v_add_f32 v194, v194, v202
    v_cndmask_b32 v145, v140, v145, s[50:51]
    v_mfma_f32_16x16x32_bf16 v[76:79], a[92:95], v[44:47], v[76:79]
    v_add_f32 v195, v195, v203
    v_cndmask_b32 v146, v140, v146, s[52:53]
    v_mfma_f32_16x16x32_bf16 v[80:83], v[44:47], a[156:159], v[80:83]
    s_waitcnt lgkmcnt(4)
    ds_read_b128 v[40:43], v222 offset:33536
    buffer_load_dwordx4 v235, s[16:19], s86 offen offset:3096 lds
    v_mfma_f32_16x16x32_bf16 v[72:75], a[32:35], v[16:19], v[72:75]
    v_add_u32 v192, 0x80, v192
    v_cndmask_b32 v147, v140, v147, s[54:55]
    v_mfma_f32_16x16x32_bf16 v[76:79], a[96:99], v[16:19], v[76:79]
    v_add_u32 v193, 0x80, v193
    v_add_u32 v194, 0x80, v194
    v_mfma_f32_16x16x32_bf16 v[80:83], v[16:19], a[160:163], v[80:83]
    ds_read_b128 v[44:47], v223 offset:33536
    v_cndmask_b32 v148, v140, v148, s[64:65]
    v_mfma_f32_16x16x32_bf16 v[72:75], a[36:39], v[20:23], v[72:75]
    v_add_u32 v195, 0x80, v195
    v_cndmask_b32 v149, v140, v149, s[66:67]
    v_mfma_f32_16x16x32_bf16 v[76:79], a[100:103], v[20:23], v[76:79]
    s_mov_b32 s96, 117835008
    v_cndmask_b32 v150, v140, v150, s[68:69]
    v_perm_b32 v208, v192, v252, s96
    v_mfma_f32_16x16x32_bf16 v[80:83], v[20:23], a[164:167], v[80:83]
    s_waitcnt lgkmcnt(4)
    ds_read_b128 v[16:19], v220 offset:49152
    v_cndmask_b32 v151, v140, v151, s[70:71]
    v_mfma_f32_16x16x32_bf16 v[72:75], a[40:43], v[24:27], v[72:75]
    s_add_u32 s86, s86, 32768
    s_add_u32 m0, s1, 4128
    v_mfma_f32_16x16x32_bf16 v[76:79], a[104:107], v[24:27], v[76:79]
    buffer_load_dwordx4 v232, s[16:19], s86 offen offset:0 lds
    s_mov_b32 s96, 117835009
    v_mfma_f32_16x16x32_bf16 v[80:83], v[24:27], a[168:171], v[80:83]
    ds_read_b128 v[20:23], v221 offset:49152
    v_max3_f32 v152, v144, v145, v146
    v_mfma_f32_16x16x32_bf16 v[72:75], a[44:47], v[28:31], v[72:75]
    v_perm_b32 v209, v193, v252, s96
    v_max3_f32 v153, v147, v148, v149
    v_mfma_f32_16x16x32_bf16 v[76:79], a[108:111], v[28:31], v[76:79]
    s_mov_b32 s96, 117835010
    v_max3_f32 v152, v152, v150, v151
    v_perm_b32 v210, v194, v252, s96
    v_mfma_f32_16x16x32_bf16 v[80:83], v[28:31], a[172:175], v[80:83]
    s_waitcnt lgkmcnt(4)
    ds_read_b128 v[24:27], v222 offset:49152
    s_mov_b32 s96, 117835011
    v_mfma_f32_16x16x32_bf16 v[72:75], a[48:51], v[32:35], v[72:75]
    v_max_f32 v152, v152, v153
    v_perm_b32 v211, v195, v252, s96
    v_mfma_f32_16x16x32_bf16 v[76:79], a[112:115], v[32:35], v[76:79]
    buffer_load_dwordx4 v233, s[16:19], s86 offen offset:1032 lds
    v_mov_b32 v153, v152
    v_mfma_f32_16x16x32_bf16 v[80:83], v[32:35], a[176:179], v[80:83]
    ds_read_b128 v[28:31], v223 offset:49152
    s_lshr_b32 s96, s3, 1
    v_mfma_f32_16x16x32_bf16 v[72:75], a[52:55], v[36:39], v[72:75]
    v_permlane32_swap_b32 v152, v153
    v_mfma_f32_16x16x32_bf16 v[76:79], a[116:119], v[36:39], v[76:79]
    s_mul_i32 s96, s96, 12288
    v_max_f32 v152, v152, v153
    s_lshl_b32 s97, s101, 8
    v_mfma_f32_16x16x32_bf16 v[80:83], v[36:39], a[180:183], v[80:83]
    s_waitcnt lgkmcnt(4)
    ds_read_b128 v[32:35], v220 offset:49408
    v_mov_b32 v153, v152
    v_mfma_f32_16x16x32_bf16 v[72:75], a[56:59], v[40:43], v[72:75]
    s_add_u32 s96, s96, s97
    v_permlane16_swap_b32 v152, v153
    v_mfma_f32_16x16x32_bf16 v[76:79], a[120:123], v[40:43], v[76:79]
    s_add_u32 s96, s96, 589824
    v_max_f32 v152, v152, v153
    v_mfma_f32_16x16x32_bf16 v[80:83], v[40:43], a[184:187], v[80:83]
    ds_read_b128 v[36:39], v221 offset:49408
    buffer_load_dwordx4 v234, s[16:19], s86 offen offset:2064 lds
    v_mfma_f32_16x16x32_bf16 v[72:75], a[60:63], v[44:47], v[72:75]
    buffer_store_dwordx4 v[208:211], v10, s[36:39], s96 offen sc1
    v_mul_f32 v152, s80, v152
    v_mfma_f32_16x16x32_bf16 v[76:79], a[124:127], v[44:47], v[76:79]
    v_fma_f32 v144, v144, s80, -v152
    v_fma_f32 v145, v145, s80, -v152
    v_mfma_f32_16x16x32_bf16 v[80:83], v[44:47], a[188:191], v[80:83]
    v_fma_f32 v146, v146, s80, -v152
    v_fma_f32 v147, v147, s80, -v152
    v_fma_f32 v148, v148, s80, -v152
    v_fma_f32 v149, v149, s80, -v152
    v_fma_f32 v150, v150, s80, -v152
    v_fma_f32 v151, v151, s80, -v152
    buffer_load_dwordx4 v235, s[16:19], s86 offen offset:3096 lds
    v_exp_f32 v144, v144
    v_exp_f32 v145, v145
    v_exp_f32 v146, v146
    v_exp_f32 v147, v147
    v_exp_f32 v148, v148
    v_exp_f32 v149, v149
    v_exp_f32 v150, v150
    v_exp_f32 v151, v151
    v_cvt_pk_bf16_f32 v156, v144, v145
    v_cvt_pk_bf16_f32 v157, v146, v147
    v_cvt_pk_bf16_f32 v158, v148, v149
    s_lshl_b32 s93, s4, 2
    s_add_u32 s93, s93, s5
    s_mul_i32 s93, s93, 3584
    v_min_u32 v3, 27, v0
    v_lshl_add_u32 v3, v3, 7, s93
    s_mov_b32 s93, 1376256
    buffer_load_dword v255, v3, s[20:23], s93 offen
    v_cvt_pk_bf16_f32 v159, v150, v151
    s_nop 1
    v_mfma_f32_16x16x32_bf16 v[160:163], v[136:139], v[156:159], 0
    v_mfma_f32_16x16x32_bf16 v[164:167], v[128:131], v[156:159], 0
    s_nop 6
    v_rcp_f32 v160, v160
    s_nop 0
    v_mul_f32 v164, v164, v160
    v_mul_f32 v165, v165, v160
    v_mul_f32 v166, v166, v160
    v_mul_f32 v167, v167, v160
    v_cvt_pk_bf16_f32 v168, v164, v165
    v_cvt_pk_bf16_f32 v169, v166, v167
    buffer_store_dwordx2 v[168:169], v231, s[36:39], s81 offen sc1
    s_waitcnt lgkmcnt(4)
    ds_read_b128 v[40:43], v222 offset:49408
    v_mfma_f32_16x16x32_bf16 v[84:87], a[0:3], v[16:19], 0
    s_add_u32 s86, s86, 32768
    s_add_u32 m0, s1, 8256
    v_mfma_f32_16x16x32_bf16 v[88:91], a[64:67], v[16:19], 0
    buffer_load_dwordx4 v232, s[16:19], s86 offen offset:0 lds
    v_cvt_pk_bf16_f32 v110, v72, v73
    v_mfma_f32_16x16x32_bf16 v[92:95], v[16:19], a[128:131], 0
    s_waitcnt vmcnt(15)
    ds_read_b128 v[44:47], v223 offset:49408
    v_cvt_pk_bf16_f32 v120, v76, v77
    v_mfma_f32_16x16x32_bf16 v[84:87], a[4:7], v[20:23], v[84:87]
    v_cvt_pk_bf16_f32 v111, v74, v75
    v_cvt_pk_bf16_f32 v121, v78, v79
    v_mfma_f32_16x16x32_bf16 v[88:91], a[68:71], v[20:23], v[88:91]
    buffer_load_dwordx4 v233, s[16:19], s86 offen offset:1032 lds
    ds_read_b64_tr_b16 v[240:241], v8 offset:0
    v_mfma_f32_16x16x32_bf16 v[92:95], v[20:23], a[132:135], v[92:95]
    s_waitcnt lgkmcnt(5)
    v_cvt_pk_bf16_f32 v132, v80, v81
    v_cvt_pk_bf16_f32 v133, v82, v83
    v_mfma_f32_16x16x16_bf16 v[144:147], v[120:121], v[110:111], 0
    ds_read_b128 v[16:19], v220 offset:49664
    ds_read_b64_tr_b16 v[242:243], v8 offset:512
    v_mfma_f32_16x16x32_bf16 v[84:87], a[8:11], v[24:27], v[84:87]
    buffer_load_dwordx4 v234, s[16:19], s86 offen offset:2064 lds
    v_mfma_f32_16x16x16_bf16 v[148:151], v[116:117], v[110:111], 0
    v_mfma_f32_16x16x32_bf16 v[88:91], a[72:75], v[24:27], v[88:91]
    v_mfma_f32_16x16x32_bf16 v[92:95], v[24:27], a[136:139], v[92:95]
    ds_read_b128 v[20:23], v221 offset:49664
    v_cndmask_b32 v144, v140, v144, s[48:49]
    v_mfma_f32_16x16x32_bf16 v[84:87], a[12:15], v[28:31], v[84:87]
    v_cndmask_b32 v145, v140, v145, s[50:51]
    v_cndmask_b32 v146, v140, v146, s[52:53]
    v_mfma_f32_16x16x32_bf16 v[88:91], a[76:79], v[28:31], v[88:91]
    ds_read_b64_tr_b16 v[244:245], v8 offset:64
    buffer_load_dwordx4 v235, s[16:19], s86 offen offset:3096 lds
    v_mfma_f32_16x16x32_bf16 v[92:95], v[28:31], a[140:143], v[92:95]
    s_waitcnt lgkmcnt(7)
    ds_read_b128 v[24:27], v222 offset:49664
    v_cndmask_b32 v147, v140, v147, s[54:55]
    v_mfma_f32_16x16x32_bf16 v[84:87], a[16:19], v[32:35], v[84:87]
    v_cndmask_b32 v148, v140, v148, s[72:73]
    v_cndmask_b32 v149, v140, v149, s[74:75]
    v_mfma_f32_16x16x32_bf16 v[88:91], a[80:83], v[32:35], v[88:91]
    ds_read_b64_tr_b16 v[246:247], v8 offset:576
    v_cndmask_b32 v150, v140, v150, s[76:77]
    v_mfma_f32_16x16x32_bf16 v[92:95], v[32:35], a[144:147], v[92:95]
    s_add_u32 s86, s86, 32768
    ds_read_b128 v[28:31], v223 offset:49664
    s_add_u32 m0, s1, 12384
    v_mfma_f32_16x16x32_bf16 v[84:87], a[20:23], v[36:39], v[84:87]
    buffer_load_dwordx4 v232, s[16:19], s86 offen offset:0 lds
    v_cndmask_b32 v151, v140, v151, s[78:79]
    v_mfma_f32_16x16x32_bf16 v[88:91], a[84:87], v[36:39], v[88:91]
    v_max3_f32 v152, v144, v145, v146
    v_max3_f32 v153, v147, v148, v149
    v_mfma_f32_16x16x32_bf16 v[92:95], v[36:39], a[148:151], v[92:95]
    s_waitcnt lgkmcnt(8)
    ds_read_b128 v[32:35], v220 offset:49920
    s_mul_i32 s94, s3, 112
    v_mfma_f32_16x16x32_bf16 v[84:87], a[24:27], v[40:43], v[84:87]
    v_max3_f32 v152, v152, v150, v151
    v_mfma_f32_16x16x32_bf16 v[88:91], a[88:91], v[40:43], v[88:91]
    buffer_load_dwordx4 v233, s[16:19], s86 offen offset:1032 lds
    v_max_f32 v152, v152, v153
    v_mfma_f32_16x16x32_bf16 v[92:95], v[40:43], a[152:155], v[92:95]
    ds_read_b128 v[36:39], v221 offset:49920
    v_mov_b32 v153, v152
    v_mfma_f32_16x16x32_bf16 v[84:87], a[28:31], v[44:47], v[84:87]
    s_lshl_b32 s95, s4, 2
    v_permlane32_swap_b32 v152, v153
    v_mfma_f32_16x16x32_bf16 v[88:91], a[92:95], v[44:47], v[88:91]
    v_max_f32 v152, v152, v153
    v_mfma_f32_16x16x32_bf16 v[92:95], v[44:47], a[156:159], v[92:95]
    s_waitcnt lgkmcnt(6)
    ds_read_b128 v[40:43], v222 offset:49920
    buffer_load_dwordx4 v234, s[16:19], s86 offen offset:2064 lds
    v_mfma_f32_16x16x32_bf16 v[84:87], a[32:35], v[16:19], v[84:87]
    v_mov_b32 v153, v152
    s_add_u32 s94, s94, s95
    v_mfma_f32_16x16x32_bf16 v[88:91], a[96:99], v[16:19], v[88:91]
    v_permlane16_swap_b32 v152, v153
    v_mfma_f32_16x16x32_bf16 v[92:95], v[16:19], a[160:163], v[92:95]
    ds_read_b128 v[44:47], v223 offset:49920
    v_max_f32 v152, v152, v153
    v_mfma_f32_16x16x32_bf16 v[84:87], a[36:39], v[20:23], v[84:87]
    v_mul_f32 v152, s80, v152
    v_mfma_f32_16x16x32_bf16 v[88:91], a[100:103], v[20:23], v[88:91]
    buffer_load_dwordx4 v235, s[16:19], s86 offen offset:3096 lds
    v_fma_f32 v144, v144, s80, -v152
    v_mfma_f32_16x16x32_bf16 v[92:95], v[20:23], a[164:167], v[92:95]
    s_waitcnt lgkmcnt(4)
    v_add_u32 v220, 16384, v220
    v_add_u32 v221, 16384, v221
    v_add_u32 v222, 16384, v222
    v_add_u32 v223, 16384, v223
    s_add_u32 s94, s94, s5
    ds_read_b128 v[16:19], v220 offset:49152
    v_mfma_f32_16x16x32_bf16 v[84:87], a[40:43], v[24:27], v[84:87]
    v_fma_f32 v145, v145, s80, -v152
    v_fma_f32 v146, v146, s80, -v152
    v_mfma_f32_16x16x32_bf16 v[88:91], a[104:107], v[24:27], v[88:91]
    v_fma_f32 v147, v147, s80, -v152
    s_add_u32 s92, s5, 4
    v_mfma_f32_16x16x32_bf16 v[92:95], v[24:27], a[168:171], v[92:95]
    s_mul_i32 s93, s92, 7168
    ds_read_b128 v[20:23], v221 offset:49152
    s_mul_i32 s92, s92, 114688
    v_mfma_f32_16x16x32_bf16 v[84:87], a[44:47], v[28:31], v[84:87]
    s_add_u32 m0, s93, 37376
    v_mfma_f32_16x16x32_bf16 v[88:91], a[108:111], v[28:31], v[88:91]
    buffer_load_dwordx4 v224, s[20:23], s92 offen offset:0 lds
    s_lshl_b32 s94, s94, 11
    v_mfma_f32_16x16x32_bf16 v[92:95], v[28:31], a[172:175], v[92:95]
    s_waitcnt lgkmcnt(4)
    ds_read_b128 v[24:27], v222 offset:49152
    v_fma_f32 v148, v148, s80, -v152
    v_mfma_f32_16x16x32_bf16 v[84:87], a[48:51], v[32:35], v[84:87]
    v_fma_f32 v149, v149, s80, -v152
    v_fma_f32 v150, v150, s80, -v152
    v_mfma_f32_16x16x32_bf16 v[88:91], a[112:115], v[32:35], v[88:91]
    v_fma_f32 v151, v151, s80, -v152
    v_mfma_f32_16x16x32_bf16 v[92:95], v[32:35], a[176:179], v[92:95]
    ds_read_b128 v[28:31], v223 offset:49152
    buffer_load_dwordx4 v225, s[20:23], s92 offen offset:1024 lds
    v_mfma_f32_16x16x32_bf16 v[84:87], a[52:55], v[36:39], v[84:87]
    s_add_u32 s94, s94, 12582912
    v_exp_f32 v144, v144
    v_mfma_f32_16x16x32_bf16 v[88:91], a[116:119], v[36:39], v[88:91]
    v_exp_f32 v145, v145
    v_mfma_f32_16x16x32_bf16 v[92:95], v[36:39], a[180:183], v[92:95]
    s_waitcnt lgkmcnt(4)
    ds_read_b128 v[32:35], v220 offset:49408
    v_mfma_f32_16x16x32_bf16 v[84:87], a[56:59], v[40:43], v[84:87]
    v_exp_f32 v146, v146
    v_mfma_f32_16x16x32_bf16 v[88:91], a[120:123], v[40:43], v[88:91]
    s_cmp_lt_u32 s4, 28
    buffer_load_dwordx4 v226, s[20:23], s92 offen offset:2048 lds
    v_mfma_f32_16x16x32_bf16 v[92:95], v[40:43], a[184:187], v[92:95]
    ds_read_b128 v[36:39], v221 offset:49408
    v_mfma_f32_16x16x32_bf16 v[84:87], a[60:63], v[44:47], v[84:87]
    v_exp_f32 v147, v147
    v_mfma_f32_16x16x32_bf16 v[88:91], a[124:127], v[44:47], v[88:91]
    v_exp_f32 v148, v148
    v_mfma_f32_16x16x32_bf16 v[92:95], v[44:47], a[188:191], v[92:95]
    v_exp_f32 v149, v149
    s_cselect_b32 s95, 0, 0x10000000
    v_exp_f32 v150, v150
    buffer_load_dwordx4 v227, s[20:23], s92 offen offset:3072 lds
    v_exp_f32 v151, v151
    v_cvt_pk_bf16_f32 v156, v148, v149
    v_cvt_pk_bf16_f32 v157, v150, v151
    s_cselect_b32 s94, s94, 0
    v_cvt_pk_bf16_f32 v158, v144, v145
    s_add_u32 m0, s93, 41472
    s_nop 0
    buffer_load_dwordx4 v228, s[20:23], s92 offen offset:0 lds
    v_cvt_pk_bf16_f32 v159, v146, v147
    s_nop 1
    v_mfma_f32_16x16x32_bf16 v[160:163], v[136:139], v[156:159], 0
    v_add_u32 v15, s95, v1
    v_mfma_f32_16x16x32_bf16 v[164:167], v[130:133], v[156:159], 0
    s_nop 5
    v_rcp_f32 v160, v160
    buffer_load_dwordx4 v229, s[20:23], s92 offen offset:1024 lds
    v_mul_f32 v164, v164, v160
    v_mul_f32 v165, v165, v160
    buffer_store_dwordx4 v[240:243], v15, s[36:39], s94 offen offset:0 sc1
    v_mul_f32 v166, v166, v160
    v_mul_f32 v167, v167, v160
    buffer_load_dwordx4 v230, s[20:23], s92 offen offset:2048 lds
    v_cvt_pk_bf16_f32 v170, v164, v165
    buffer_store_dwordx4 v[244:247], v15, s[36:39], s94 offen offset:1024 sc1
    v_cvt_pk_bf16_f32 v171, v166, v167
    s_add_u32 s81, s81, 16384
    buffer_store_dwordx2 v[170:171], v231, s[36:39], s81 offen sc1
    s_waitcnt lgkmcnt(4)
    ds_read_b128 v[40:43], v222 offset:49408
    v_mfma_f32_16x16x32_bf16 v[96:99], a[0:3], v[16:19], 0
    s_mul_i32 s94, s91, 112
    s_lshl_b32 s95, s5, 4
    s_add_u32 s94, s94, s95
    v_mfma_f32_16x16x32_bf16 v[100:103], a[64:67], v[16:19], 0
    v_and_b32 v4, 15, v0
    v_add_u32 v4, s94, v4
    v_mfma_f32_16x16x32_bf16 v[104:107], v[16:19], a[128:131], 0
    ds_read_b128 v[44:47], v223 offset:49408
    v_add_u32 v5, 64, v4
    v_mfma_f32_16x16x32_bf16 v[96:99], a[4:7], v[20:23], v[96:99]
    v_min_u32 v5, 1791, v5
    v_lshlrev_b32 v4, 1, v4
    v_mfma_f32_16x16x32_bf16 v[100:103], a[68:71], v[20:23], v[100:103]
    v_lshlrev_b32 v5, 1, v5
    v_mfma_f32_16x16x32_bf16 v[104:107], v[20:23], a[132:135], v[104:107]
    s_waitcnt lgkmcnt(4)
    ds_read_b128 v[16:19], v220 offset:49664
    global_load_ushort v246, v4, s[42:43]
    v_mfma_f32_16x16x32_bf16 v[96:99], a[8:11], v[24:27], v[96:99]
    v_cvt_pk_bf16_f32 v112, v84, v85
    v_cvt_pk_bf16_f32 v122, v88, v89
    v_mfma_f32_16x16x32_bf16 v[100:103], a[72:75], v[24:27], v[100:103]
    v_cvt_pk_bf16_f32 v113, v86, v87
    v_mfma_f32_16x16x32_bf16 v[104:107], v[24:27], a[136:139], v[104:107]
    ds_read_b128 v[20:23], v221 offset:49664
    global_load_ushort v247, v5, s[42:43]
    v_mfma_f32_16x16x32_bf16 v[96:99], a[12:15], v[28:31], v[96:99]
    v_cvt_pk_bf16_f32 v123, v90, v91
    v_cvt_pk_bf16_f32 v126, v92, v93
    v_mfma_f32_16x16x32_bf16 v[100:103], a[76:79], v[28:31], v[100:103]
    v_cvt_pk_bf16_f32 v127, v94, v95
    v_mfma_f32_16x16x16_bf16 v[144:147], v[122:123], v[112:113], 0
    s_lshl_b32 s94, s89, 7
    v_mov_b32 v6, s94
    v_mfma_f32_16x16x32_bf16 v[104:107], v[28:31], a[140:143], v[104:107]
    s_waitcnt lgkmcnt(4)
    ds_read_b128 v[24:27], v222 offset:49664
    global_load_dword v255, v6, s[44:45]
    v_mfma_f32_16x16x16_bf16 v[148:151], v[118:119], v[112:113], 0
    v_mfma_f32_16x16x32_bf16 v[96:99], a[16:19], v[32:35], v[96:99]
    v_mfma_f32_16x16x32_bf16 v[100:103], a[80:83], v[32:35], v[100:103]
    v_cndmask_b32 v144, v140, v144, s[48:49]
    v_cndmask_b32 v145, v140, v145, s[50:51]
    v_mfma_f32_16x16x32_bf16 v[104:107], v[32:35], a[144:147], v[104:107]
    ds_read_b128 v[28:31], v223 offset:49664
    buffer_load_dwordx4 v[208:211], v7, s[8:11], s87 offen offset:0
    v_mfma_f32_16x16x32_bf16 v[96:99], a[20:23], v[36:39], v[96:99]
    v_cndmask_b32 v146, v140, v146, s[52:53]
    v_cndmask_b32 v147, v140, v147, s[54:55]
    v_mfma_f32_16x16x32_bf16 v[100:103], a[84:87], v[36:39], v[100:103]
    v_cndmask_b32 v148, v140, v148, s[56:57]
    v_cndmask_b32 v149, v140, v149, s[58:59]
    v_mfma_f32_16x16x32_bf16 v[104:107], v[36:39], a[148:151], v[104:107]
    s_waitcnt lgkmcnt(4)
    ds_read_b128 v[32:35], v220 offset:49920
    buffer_load_dwordx4 v[212:215], v7, s[8:11], s87 offen offset:64
    v_mfma_f32_16x16x32_bf16 v[96:99], a[24:27], v[40:43], v[96:99]
    v_cndmask_b32 v150, v140, v150, s[60:61]
    v_cndmask_b32 v151, v140, v151, s[62:63]
    v_mfma_f32_16x16x32_bf16 v[100:103], a[88:91], v[40:43], v[100:103]
    v_max3_f32 v152, v144, v145, v146
    s_mov_b32 s82, 589824
    v_mfma_f32_16x16x32_bf16 v[104:107], v[40:43], a[152:155], v[104:107]
    s_mov_b32 s83, 602112
    ds_read_b128 v[36:39], v221 offset:49920
    s_mov_b32 s84, 614400
    v_mfma_f32_16x16x32_bf16 v[96:99], a[28:31], v[44:47], v[96:99]
    s_mov_b32 s85, 626688
    s_cmp_ge_u32 s5, 2
    s_cselect_b32 s94, 2, 1
    v_mfma_f32_16x16x32_bf16 v[100:103], a[92:95], v[44:47], v[100:103]
    s_lshl_b32 s94, s94, 12
    v_add_u32 v12, 6144, v2
    v_add_u32 v13, s94, v2
    v_mfma_f32_16x16x32_bf16 v[104:107], v[44:47], a[156:159], v[104:107]
    s_waitcnt lgkmcnt(4)
    ds_read_b128 v[40:43], v222 offset:49920
    buffer_load_dwordx4 v[176:179], v12, s[36:39], s82 offen sc1
    v_mfma_f32_16x16x32_bf16 v[96:99], a[32:35], v[16:19], v[96:99]
    v_max3_f32 v153, v147, v148, v149
    v_max3_f32 v152, v152, v150, v151
    v_mfma_f32_16x16x32_bf16 v[100:103], a[96:99], v[16:19], v[100:103]
    v_max_f32 v152, v152, v153
    v_mov_b32 v153, v152
    v_mfma_f32_16x16x32_bf16 v[104:107], v[16:19], a[160:163], v[104:107]
    ds_read_b128 v[44:47], v223 offset:49920
    buffer_load_dwordx4 v[180:183], v12, s[36:39], s83 offen sc1
    v_mfma_f32_16x16x32_bf16 v[96:99], a[36:39], v[20:23], v[96:99]
    v_permlane32_swap_b32 v152, v153
    v_mfma_f32_16x16x32_bf16 v[100:103], a[100:103], v[20:23], v[100:103]
    v_max_f32 v152, v152, v153
    v_mov_b32 v153, v152
    v_mfma_f32_16x16x32_bf16 v[104:107], v[20:23], a[164:167], v[104:107]
    s_waitcnt lgkmcnt(4)
    buffer_load_dwordx4 v[184:187], v12, s[36:39], s84 offen sc1
    v_mfma_f32_16x16x32_bf16 v[96:99], a[40:43], v[24:27], v[96:99]
    v_permlane16_swap_b32 v152, v153
    v_mfma_f32_16x16x32_bf16 v[100:103], a[104:107], v[24:27], v[100:103]
    v_max_f32 v152, v152, v153
    v_mul_f32 v152, s80, v152
    v_mfma_f32_16x16x32_bf16 v[104:107], v[24:27], a[168:171], v[104:107]
    v_fma_f32 v144, v144, s80, -v152
    v_mfma_f32_16x16x32_bf16 v[96:99], a[44:47], v[28:31], v[96:99]
    buffer_load_dwordx4 v[188:191], v12, s[36:39], s85 offen sc1
    v_fma_f32 v145, v145, s80, -v152
    v_mfma_f32_16x16x32_bf16 v[100:103], a[108:111], v[28:31], v[100:103]
    v_fma_f32 v146, v146, s80, -v152
    v_fma_f32 v147, v147, s80, -v152
    v_mfma_f32_16x16x32_bf16 v[104:107], v[28:31], a[172:175], v[104:107]
    s_waitcnt lgkmcnt(2)
    buffer_load_dwordx4 v[192:195], v13, s[36:39], s82 offen sc1
    v_fma_f32 v148, v148, s80, -v152
    v_mfma_f32_16x16x32_bf16 v[96:99], a[48:51], v[32:35], v[96:99]
    v_fma_f32 v149, v149, s80, -v152
    v_fma_f32 v150, v150, s80, -v152
    v_mfma_f32_16x16x32_bf16 v[100:103], a[112:115], v[32:35], v[100:103]
    v_fma_f32 v151, v151, s80, -v152
    v_mfma_f32_16x16x32_bf16 v[104:107], v[32:35], a[176:179], v[104:107]
    buffer_load_dwordx4 v[196:199], v13, s[36:39], s83 offen sc1
    v_mfma_f32_16x16x32_bf16 v[96:99], a[52:55], v[36:39], v[96:99]
    v_exp_f32 v144, v144
    v_mfma_f32_16x16x32_bf16 v[100:103], a[116:119], v[36:39], v[100:103]
    v_exp_f32 v145, v145
    v_mfma_f32_16x16x32_bf16 v[104:107], v[36:39], a[180:183], v[104:107]
    s_waitcnt lgkmcnt(0)
    v_exp_f32 v146, v146
    v_mfma_f32_16x16x32_bf16 v[96:99], a[56:59], v[40:43], v[96:99]
    buffer_load_dwordx4 v[200:203], v13, s[36:39], s84 offen sc1
    v_mfma_f32_16x16x32_bf16 v[100:103], a[120:123], v[40:43], v[100:103]
    v_exp_f32 v147, v147
    v_mfma_f32_16x16x32_bf16 v[104:107], v[40:43], a[184:187], v[104:107]
    v_exp_f32 v148, v148
    v_mfma_f32_16x16x32_bf16 v[96:99], a[60:63], v[44:47], v[96:99]
    v_exp_f32 v149, v149
    v_mfma_f32_16x16x32_bf16 v[100:103], a[124:127], v[44:47], v[100:103]
    v_exp_f32 v150, v150
    v_mfma_f32_16x16x32_bf16 v[104:107], v[44:47], a[188:191], v[104:107]
    buffer_load_dwordx4 v[204:207], v13, s[36:39], s85 offen sc1
    v_exp_f32 v151, v151
    v_cvt_pk_bf16_f32 v156, v144, v145
    v_cvt_pk_bf16_f32 v157, v146, v147
    v_cvt_pk_bf16_f32 v158, v148, v149
    v_cvt_pk_bf16_f32 v159, v150, v151
    s_nop 1
    v_mfma_f32_16x16x32_bf16 v[160:163], v[136:139], v[156:159], 0
    v_mfma_f32_16x16x32_bf16 v[164:167], v[126:129], v[156:159], 0
    s_nop 6
    v_rcp_f32 v160, v160
    s_nop 0
    v_mul_f32 v164, v164, v160
    v_mul_f32 v165, v165, v160
    v_mul_f32 v166, v166, v160
    v_mul_f32 v167, v167, v160
    v_cvt_pk_bf16_f32 v172, v164, v165
    v_cvt_pk_bf16_f32 v173, v166, v167
    s_add_u32 s81, s81, 16384
    buffer_store_dwordx2 v[172:173], v231, s[36:39], s81 offen sc1
    v_cvt_pk_bf16_f32 v114, v96, v97
    v_cvt_pk_bf16_f32 v124, v100, v101
    v_cvt_pk_bf16_f32 v115, v98, v99
    v_cvt_pk_bf16_f32 v125, v102, v103
    v_cvt_pk_bf16_f32 v134, v104, v105
    v_cvt_pk_bf16_f32 v135, v106, v107
    v_mfma_f32_16x16x16_bf16 v[144:147], v[124:125], v[114:115], 0
    v_mfma_f32_16x16x16_bf16 v[148:151], v[120:121], v[114:115], 0
    s_nop 6
    v_cndmask_b32 v144, v140, v144, s[48:49]
    v_cndmask_b32 v145, v140, v145, s[50:51]
    v_cndmask_b32 v146, v140, v146, s[52:53]
    v_cndmask_b32 v147, v140, v147, s[54:55]
    v_cndmask_b32 v148, v140, v148, s[56:57]
    v_cndmask_b32 v149, v140, v149, s[58:59]
    v_cndmask_b32 v150, v140, v150, s[60:61]
    v_cndmask_b32 v151, v140, v151, s[62:63]
    v_max3_f32 v152, v144, v145, v146
    v_max3_f32 v153, v147, v148, v149
    v_max3_f32 v152, v152, v150, v151
    v_max_f32 v152, v152, v153
    v_mov_b32 v153, v152
    s_nop 1
    v_permlane32_swap_b32 v152, v153
    v_max_f32 v152, v152, v153
    v_mov_b32 v153, v152
    s_nop 1
    v_permlane16_swap_b32 v152, v153
    v_max_f32 v152, v152, v153
    v_mul_f32 v152, s80, v152
    v_fma_f32 v144, v144, s80, -v152
    v_fma_f32 v145, v145, s80, -v152
    v_fma_f32 v146, v146, s80, -v152
    v_fma_f32 v147, v147, s80, -v152
    v_fma_f32 v148, v148, s80, -v152
    v_fma_f32 v149, v149, s80, -v152
    v_fma_f32 v150, v150, s80, -v152
    v_fma_f32 v151, v151, s80, -v152
    v_exp_f32 v144, v144
    v_exp_f32 v145, v145
    v_exp_f32 v146, v146
    v_exp_f32 v147, v147
    v_exp_f32 v148, v148
    v_exp_f32 v149, v149
    v_exp_f32 v150, v150
    v_exp_f32 v151, v151
    v_cvt_pk_bf16_f32 v156, v148, v149
    v_cvt_pk_bf16_f32 v157, v150, v151
    v_cvt_pk_bf16_f32 v158, v144, v145
    v_cvt_pk_bf16_f32 v159, v146, v147
    s_nop 1
    v_mfma_f32_16x16x32_bf16 v[160:163], v[136:139], v[156:159], 0
    v_mfma_f32_16x16x32_bf16 v[164:167], v[132:135], v[156:159], 0
    s_nop 6
    v_rcp_f32 v160, v160
    s_nop 0
    v_mul_f32 v164, v164, v160
    v_mul_f32 v165, v165, v160
    v_mul_f32 v166, v166, v160
    v_mul_f32 v167, v167, v160
    v_cvt_pk_bf16_f32 v174, v164, v165
    v_cvt_pk_bf16_f32 v175, v166, v167
    s_add_u32 s81, s81, 16384
    buffer_store_dwordx2 v[174:175], v231, s[36:39], s81 offen sc1
    s_lshl_b32 s96, s88, 3
    s_add_u32 s96, s96, s89
    s_lshl_b32 s96, s96, 2
    s_add_u32 s96, s96, s5
    s_lshl_b32 s96, s96, 2
    s_add_u32 s96, s96, 32768
    s_lshl_b32 s97, s3, 5
    s_add_u32 s97, s97, s4
    s_lshl_b32 s97, s97, 2
    s_add_u32 s97, s97, s5
    s_lshl_b32 s97, s97, 2
    s_add_u32 s97, s97, 4096
    v_lshrrev_b32 v9, 1, v2
    v_add_u32 v9, 159744, v9
    s_cmp_ge_u32 s5, 2
    s_cselect_b32 s94, 2048, 0
    v_add_u32 v10, s94, v9
    s_waitcnt vmcnt(25)
    s_barrier
    ds_read_b64_tr_b16 a[0:1], v236 offset:0
    ds_read_b64_tr_b16 a[2:3], v236 offset:512
    ds_read_b64_tr_b16 a[4:5], v236 offset:8
    ds_read_b64_tr_b16 a[6:7], v236 offset:520
    ds_read_b64_tr_b16 a[8:9], v237 offset:0
    ds_read_b64_tr_b16 a[10:11], v237 offset:512
    ds_read_b64_tr_b16 a[12:13], v237 offset:8
    ds_read_b64_tr_b16 a[14:15], v237 offset:520
    ds_read_b64_tr_b16 a[16:17], v236 offset:4128
    ds_read_b64_tr_b16 a[18:19], v236 offset:4640
    ds_read_b64_tr_b16 a[20:21], v236 offset:4136
    ds_read_b64_tr_b16 a[22:23], v236 offset:4648
    ds_read_b64_tr_b16 a[24:25], v237 offset:4128
    ds_read_b64_tr_b16 a[26:27], v237 offset:4640
    ds_read_b64_tr_b16 a[28:29], v237 offset:4136
    ds_read_b64_tr_b16 a[30:31], v237 offset:4648
    ds_read_b64_tr_b16 a[32:33], v236 offset:8256
    ds_read_b64_tr_b16 a[34:35], v236 offset:8768
    ds_read_b64_tr_b16 a[36:37], v236 offset:8264
    ds_read_b64_tr_b16 a[38:39], v236 offset:8776
    ds_read_b64_tr_b16 a[40:41], v237 offset:8256
    ds_read_b64_tr_b16 a[42:43], v237 offset:8768
    ds_read_b64_tr_b16 a[44:45], v237 offset:8264
    ds_read_b64_tr_b16 a[46:47], v237 offset:8776
    ds_read_b64_tr_b16 a[48:49], v236 offset:12384
    ds_read_b64_tr_b16 a[50:51], v236 offset:12896
    ds_read_b64_tr_b16 a[52:53], v236 offset:12392
    ds_read_b64_tr_b16 a[54:55], v236 offset:12904
    ds_read_b64_tr_b16 a[56:57], v237 offset:12384
    ds_read_b64_tr_b16 a[58:59], v237 offset:12896
    ds_read_b64_tr_b16 a[60:61], v237 offset:12392
    ds_read_b64_tr_b16 a[62:63], v237 offset:12904
    ds_read_b64_tr_b16 a[64:65], v236 offset:16512
    ds_read_b64_tr_b16 a[66:67], v236 offset:17024
    ds_read_b64_tr_b16 a[68:69], v236 offset:16520
    ds_read_b64_tr_b16 a[70:71], v236 offset:17032
    ds_read_b64_tr_b16 a[72:73], v237 offset:16512
    ds_read_b64_tr_b16 a[74:75], v237 offset:17024
    ds_read_b64_tr_b16 a[76:77], v237 offset:16520
    ds_read_b64_tr_b16 a[78:79], v237 offset:17032
    ds_read_b64_tr_b16 a[80:81], v236 offset:20640
    ds_read_b64_tr_b16 a[82:83], v236 offset:21152
    ds_read_b64_tr_b16 a[84:85], v236 offset:20648
    ds_read_b64_tr_b16 a[86:87], v236 offset:21160
    ds_read_b64_tr_b16 a[88:89], v237 offset:20640
    ds_read_b64_tr_b16 a[90:91], v237 offset:21152
    ds_read_b64_tr_b16 a[92:93], v237 offset:20648
    ds_read_b64_tr_b16 a[94:95], v237 offset:21160
    s_mov_b64 exec, 1
    s_waitcnt vmcnt(0)
    buffer_store_dword v252, off, s[36:39], s96
    s_sub_u32 s96, s96, 12288
    buffer_store_dword v252, off, s[36:39], s96 sc1
    buffer_store_dword v252, off, s[36:39], s97 sc1
    s_mov_b64 exec, -1
    v_perm_b32 v48, v177, v176, s40
    v_perm_b32 v49, v179, v178, s40
    v_perm_b32 v50, v181, v180, s40
    v_perm_b32 v51, v183, v182, s40
    v_perm_b32 v52, v185, v184, s40
    v_perm_b32 v53, v187, v186, s40
    v_perm_b32 v54, v189, v188, s40
    v_perm_b32 v55, v191, v190, s40
    v_lshl_or_b32 v48, v49, 16, v48
    v_lshl_or_b32 v50, v51, 16, v50
    v_lshl_or_b32 v52, v53, 16, v52
    v_lshl_or_b32 v54, v55, 16, v54
    v_min3_u32 v49, v48, v50, v52
    v_max3_u32 v51, v48, v50, v52
    v_min_u32 v49, v49, v54
    v_max_u32 v51, v51, v54
    v_perm_b32 v56, v193, v192, s40
    v_perm_b32 v57, v195, v194, s40
    v_perm_b32 v58, v197, v196, s40
    v_perm_b32 v59, v199, v198, s40
    v_perm_b32 v60, v201, v200, s40
    v_perm_b32 v61, v203, v202, s40
    v_perm_b32 v62, v205, v204, s40
    v_perm_b32 v63, v207, v206, s40
    v_lshl_or_b32 v56, v57, 16, v56
    v_lshl_or_b32 v58, v59, 16, v58
    v_lshl_or_b32 v60, v61, 16, v60
    v_lshl_or_b32 v62, v63, 16, v62
    v_min3_u32 v57, v56, v58, v60
    v_max3_u32 v59, v56, v58, v60
    v_min_u32 v57, v57, v62
    v_max_u32 v59, v59, v62
    v_cmp_ne_u32 vcc, s6, v49
    v_cmp_ne_u32 s[98:99], s6, v51
    s_nop 0
    s_or_b64 vcc, vcc, s[98:99]
    v_cmp_ne_u32 s[98:99], s6, v57
    s_nop 0
    s_or_b64 vcc, vcc, s[98:99]
    v_cmp_ne_u32 s[98:99], s6, v59
    s_nop 0
    s_or_b64 vcc, vcc, s[98:99]
    s_cbranch_vccnz L_spin5
L_back5:
    ds_read_b64_tr_b16 a[96:97], v236 offset:24768
    ds_read_b64_tr_b16 a[98:99], v236 offset:25280
    ds_read_b64_tr_b16 a[100:101], v236 offset:24776
    ds_read_b64_tr_b16 a[102:103], v236 offset:25288
    v_and_b32 v176, 0xffffff00, v176
    v_and_b32 v177, 0xffffff00, v177
    v_and_b32 v178, 0xffffff00, v178
    v_and_b32 v179, 0xffffff00, v179
    v_and_b32 v180, 0xffffff00, v180
    v_and_b32 v181, 0xffffff00, v181
    v_and_b32 v182, 0xffffff00, v182
    v_and_b32 v183, 0xffffff00, v183
    v_and_b32 v184, 0xffffff00, v184
    ds_read_b64_tr_b16 a[104:105], v237 offset:24768
    ds_read_b64_tr_b16 a[106:107], v237 offset:25280
    ds_read_b64_tr_b16 a[108:109], v237 offset:24776
    ds_read_b64_tr_b16 a[110:111], v237 offset:25288
    v_and_b32 v185, 0xffffff00, v185
    v_and_b32 v186, 0xffffff00, v186
    v_and_b32 v187, 0xffffff00, v187
    v_and_b32 v188, 0xffffff00, v188
    v_and_b32 v189, 0xffffff00, v189
    v_and_b32 v190, 0xffffff00, v190
    v_and_b32 v191, 0xffffff00, v191
    v_add_f32 v176, v176, v180
    v_add_f32 v177, v177, v181
    ds_read_b64_tr_b16 a[112:113], v236 offset:28896
    ds_read_b64_tr_b16 a[114:115], v236 offset:29408
    ds_read_b64_tr_b16 a[116:117], v236 offset:28904
    ds_read_b64_tr_b16 a[118:119], v236 offset:29416
    v_add_f32 v178, v178, v182
    v_add_f32 v179, v179, v183
    v_add_f32 v184, v184, v188
    v_add_f32 v185, v185, v189
    v_add_f32 v186, v186, v190
    v_add_f32 v187, v187, v191
    v_add_f32 v176, v176, v184
    v_add_f32 v177, v177, v185
    v_add_f32 v178, v178, v186
    ds_read_b64_tr_b16 a[120:121], v237 offset:28896
    ds_read_b64_tr_b16 a[122:123], v237 offset:29408
    ds_read_b64_tr_b16 a[124:125], v237 offset:28904
    ds_read_b64_tr_b16 a[126:127], v237 offset:29416
    v_add_f32 v179, v179, v187
    v_cvt_pk_bf16_f32 v180, v176, v177
    v_cvt_pk_bf16_f32 v181, v178, v179
    v_lshlrev_b32 v176, 16, v180
    v_and_b32 v177, s0, v180
    v_lshlrev_b32 v178, 16, v181
    v_and_b32 v179, s0, v181
    v_add_f32 v176, s41, v176
    v_add_f32 v177, s41, v177
    ds_read_b64_tr_b16 a[128:129], v236 offset:33024
    ds_read_b64_tr_b16 a[130:131], v236 offset:33536
    ds_read_b64_tr_b16 a[132:133], v236 offset:33032
    ds_read_b64_tr_b16 a[134:135], v236 offset:33544
    v_add_f32 v178, s41, v178
    v_add_f32 v179, s41, v179
    v_cvt_pk_bf16_f32 v180, v176, v177
    v_cvt_pk_bf16_f32 v181, v178, v179
    ds_write_b64 v9, v[180:181] offset:1024
    v_and_b32 v192, 0xffffff00, v192
    v_and_b32 v193, 0xffffff00, v193
    v_and_b32 v194, 0xffffff00, v194
    v_and_b32 v195, 0xffffff00, v195
    ds_read_b64_tr_b16 a[136:137], v237 offset:33024
    ds_read_b64_tr_b16 a[138:139], v237 offset:33536
    ds_read_b64_tr_b16 a[140:141], v237 offset:33032
    ds_read_b64_tr_b16 a[142:143], v237 offset:33544
    v_and_b32 v196, 0xffffff00, v196
    v_and_b32 v197, 0xffffff00, v197
    v_and_b32 v198, 0xffffff00, v198
    v_and_b32 v199, 0xffffff00, v199
    v_and_b32 v200, 0xffffff00, v200
    v_and_b32 v201, 0xffffff00, v201
    v_and_b32 v202, 0xffffff00, v202
    v_and_b32 v203, 0xffffff00, v203
    v_and_b32 v204, 0xffffff00, v204
    ds_read_b64_tr_b16 a[144:145], v236 offset:37152
    ds_read_b64_tr_b16 a[146:147], v236 offset:37664
    ds_read_b64_tr_b16 a[148:149], v236 offset:37160
    ds_read_b64_tr_b16 a[150:151], v236 offset:37672
    v_and_b32 v205, 0xffffff00, v205
    v_and_b32 v206, 0xffffff00, v206
    v_and_b32 v207, 0xffffff00, v207
    v_add_f32 v192, v192, v196
    v_add_f32 v193, v193, v197
    v_add_f32 v194, v194, v198
    v_add_f32 v195, v195, v199
    v_add_f32 v200, v200, v204
    v_add_f32 v201, v201, v205
    ds_read_b64_tr_b16 a[152:153], v237 offset:37152
    ds_read_b64_tr_b16 a[154:155], v237 offset:37664
    ds_read_b64_tr_b16 a[156:157], v237 offset:37160
    ds_read_b64_tr_b16 a[158:159], v237 offset:37672
    v_add_f32 v202, v202, v206
    v_add_f32 v203, v203, v207
    v_add_f32 v192, v192, v200
    v_add_f32 v193, v193, v201
    v_add_f32 v194, v194, v202
    v_add_f32 v195, v195, v203
    v_cvt_pk_bf16_f32 v196, v192, v193
    v_cvt_pk_bf16_f32 v197, v194, v195
    ds_write_b64 v10, v[196:197] offset:0
    s_add_u32 s92, s5, 8
    s_mul_i32 s93, s92, 7168
    s_mul_i32 s92, s92, 114688
    s_add_u32 m0, s93, 37376
    s_nop 0
    buffer_load_dwordx4 v224, s[20:23], s92 offen offset:0 lds
    ds_read_b64_tr_b16 a[160:161], v236 offset:41280
    ds_read_b64_tr_b16 a[162:163], v236 offset:41792
    buffer_load_dwordx4 v225, s[20:23], s92 offen offset:1024 lds
    ds_read_b64_tr_b16 a[164:165], v236 offset:41288
    ds_read_b64_tr_b16 a[166:167], v236 offset:41800
    buffer_load_dwordx4 v226, s[20:23], s92 offen offset:2048 lds
    ds_read_b64_tr_b16 a[168:169], v237 offset:41280
    ds_read_b64_tr_b16 a[170:171], v237 offset:41792
    buffer_load_dwordx4 v227, s[20:23], s92 offen offset:3072 lds
    ds_read_b64_tr_b16 a[172:173], v237 offset:41288
    ds_read_b64_tr_b16 a[174:175], v237 offset:41800
    ds_read_b64_tr_b16 a[176:177], v236 offset:45408
    s_add_u32 m0, s93, 41472
    s_nop 0
    buffer_load_dwordx4 v228, s[20:23], s92 offen offset:0 lds
    ds_read_b64_tr_b16 a[178:179], v236 offset:45920
    ds_read_b64_tr_b16 a[180:181], v236 offset:45416
    buffer_load_dwordx4 v229, s[20:23], s92 offen offset:1024 lds
    ds_read_b64_tr_b16 a[182:183], v236 offset:45928
    ds_read_b64_tr_b16 a[184:185], v237 offset:45408
    buffer_load_dwordx4 v230, s[20:23], s92 offen offset:2048 lds
    ds_read_b64_tr_b16 a[186:187], v237 offset:45920
    ds_read_b64_tr_b16 a[188:189], v237 offset:45416
    ds_read_b64_tr_b16 a[190:191], v237 offset:45928
    s_lshl_b32 s56, s88, 7
    s_add_u32 s56, s56, 32768
    v_and_b32 v9, 31, v0
    v_lshlrev_b32 v9, 2, v9
    s_lshl_b32 s97, s88, 2
    s_add_u32 s97, s97, s5
    s_lshl_b32 s96, s97, 14
    s_add_u32 s96, s96, 1048576
    buffer_load_dword v10, v9, s[36:39], s56 offen sc1
    s_lshl_b32 s93, s88, 7
    s_add_u32 s93, s93, 32768
    v_min_u32 v13, 2, v0
    v_lshlrev_b32 v13, 12, v13
    buffer_load_dword v255, v13, s[36:39], s93 offen
    ds_read_b64_tr_b16 a[192:193], v236 offset:49536
    ds_read_b64_tr_b16 a[194:195], v236 offset:50048
    ds_read_b64_tr_b16 a[196:197], v236 offset:49544
    ds_read_b64_tr_b16 a[198:199], v236 offset:50056
    ds_read_b64_tr_b16 a[200:201], v237 offset:49536
    ds_read_b64_tr_b16 a[202:203], v237 offset:50048
    ds_read_b64_tr_b16 a[204:205], v237 offset:49544
    ds_read_b64_tr_b16 a[206:207], v237 offset:50056
    ds_read_b64_tr_b16 a[208:209], v236 offset:53664
    ds_read_b64_tr_b16 a[210:211], v236 offset:54176
    ds_read_b64_tr_b16 a[212:213], v236 offset:53672
    ds_read_b64_tr_b16 a[214:215], v236 offset:54184
    ds_read_b64_tr_b16 a[216:217], v237 offset:53664
    ds_read_b64_tr_b16 a[218:219], v237 offset:54176
    ds_read_b64_tr_b16 a[220:221], v237 offset:53672
    ds_read_b64_tr_b16 a[222:223], v237 offset:54184
    ds_read_b64_tr_b16 a[224:225], v236 offset:57792
    ds_read_b64_tr_b16 a[226:227], v236 offset:58304
    ds_read_b64_tr_b16 a[228:229], v236 offset:57800
    ds_read_b64_tr_b16 a[230:231], v236 offset:58312
    ds_read_b64_tr_b16 a[232:233], v237 offset:57792
    ds_read_b64_tr_b16 a[234:235], v237 offset:58304
    ds_read_b64_tr_b16 a[236:237], v237 offset:57800
    ds_read_b64_tr_b16 a[238:239], v237 offset:58312
    ds_read_b64_tr_b16 a[240:241], v236 offset:61920
    ds_read_b64_tr_b16 a[242:243], v236 offset:62432
    ds_read_b64_tr_b16 a[244:245], v236 offset:61928
    ds_read_b64_tr_b16 a[246:247], v236 offset:62440
    ds_read_b64_tr_b16 a[248:249], v237 offset:61920
    ds_read_b64_tr_b16 a[250:251], v237 offset:62432
    ds_read_b64_tr_b16 a[252:253], v237 offset:61928
    ds_read_b64_tr_b16 a[254:255], v237 offset:62440
    s_lshl_b32 s94, s89, 7
    s_add_u32 s94, s94, 157696
    v_lshrrev_b32 v11, 4, v0
    v_lshl_add_u32 v4, v11, 4, s94
    s_waitcnt lgkmcnt(0)
    s_barrier
    ds_read_b128 v[120:123], v4 offset:2048
    ds_read_b128 v[144:147], v4 offset:4096
    ds_read_b128 v[152:155], v4 offset:3072
    ds_read_b128 v[124:127], v4 offset:2112
    ds_read_b128 v[148:151], v4 offset:4160
    ds_read_b128 v[156:159], v4 offset:3136
    s_waitcnt vmcnt(1)
    v_cmp_ne_u32 vcc, s6, v10
    s_nop 0
    s_cbranch_vccnz L_spin2
L_back2:
    buffer_load_dwordx4 v[16:19], v1, s[36:39], s96 offen offset:0 sc1
    buffer_load_dwordx4 v[20:23], v1, s[36:39], s96 offen offset:1024 sc1
    buffer_load_dwordx4 v[24:27], v1, s[36:39], s96 offen offset:2048 sc1
    buffer_load_dwordx4 v[28:31], v1, s[36:39], s96 offen offset:3072 sc1
    s_add_u32 s96, s96, 4096
    buffer_load_dwordx4 v[32:35], v1, s[36:39], s96 offen offset:0 sc1
    buffer_load_dwordx4 v[36:39], v1, s[36:39], s96 offen offset:1024 sc1
    buffer_load_dwordx4 v[40:43], v1, s[36:39], s96 offen offset:2048 sc1
    buffer_load_dwordx4 v[44:47], v1, s[36:39], s96 offen offset:3072 sc1
    s_add_u32 s96, s96, 4096
    buffer_load_dwordx4 v[48:51], v1, s[36:39], s96 offen offset:0 sc1
    s_waitcnt vmcnt(8)
    v_mfma_f32_16x16x32_bf16 v[80:83], a[0:3], v[16:19], 0
    v_mfma_f32_16x16x32_bf16 v[84:87], a[4:7], v[16:19], 0
    v_mfma_f32_16x16x32_bf16 v[88:91], a[8:11], v[16:19], 0
    v_mfma_f32_16x16x32_bf16 v[92:95], a[12:15], v[16:19], 0
    v_lshlrev_b32 v104, 16, v208
    s_waitcnt vmcnt(7)
    v_mfma_f32_16x16x32_bf16 v[80:83], a[16:19], v[20:23], v[80:83]
    buffer_load_dwordx4 v[52:55], v1, s[36:39], s96 offen offset:1024 sc1
    v_and_b32 v105, s0, v208
    v_mfma_f32_16x16x32_bf16 v[84:87], a[20:23], v[20:23], v[84:87]
    v_lshlrev_b32 v106, 16, v209
    v_and_b32 v107, s0, v209
    v_mfma_f32_16x16x32_bf16 v[88:91], a[24:27], v[20:23], v[88:91]
    buffer_load_dwordx4 v[56:59], v1, s[36:39], s96 offen offset:2048 sc1
    v_lshlrev_b32 v108, 16, v210
    v_mfma_f32_16x16x32_bf16 v[92:95], a[28:31], v[20:23], v[92:95]
    v_and_b32 v109, s0, v210
    v_lshlrev_b32 v110, 16, v211
    s_waitcnt vmcnt(8)
    v_mfma_f32_16x16x32_bf16 v[80:83], a[32:35], v[24:27], v[80:83]
    buffer_load_dwordx4 v[60:63], v1, s[36:39], s96 offen offset:3072 sc1
    v_and_b32 v111, s0, v211
    v_mfma_f32_16x16x32_bf16 v[84:87], a[36:39], v[24:27], v[84:87]
    v_lshlrev_b32 v112, 16, v212
    v_and_b32 v113, s0, v212
    v_mfma_f32_16x16x32_bf16 v[88:91], a[40:43], v[24:27], v[88:91]
    s_add_u32 s96, s96, 4096
    v_lshlrev_b32 v114, 16, v213
    v_and_b32 v115, s0, v213
    v_mfma_f32_16x16x32_bf16 v[92:95], a[44:47], v[24:27], v[92:95]
    v_lshlrev_b32 v116, 16, v214
    s_waitcnt vmcnt(8)
    v_mfma_f32_16x16x32_bf16 v[80:83], a[48:51], v[28:31], v[80:83]
    buffer_load_dwordx4 v[64:67], v1, s[36:39], s96 offen offset:0 sc1
    v_and_b32 v117, s0, v214
    v_mfma_f32_16x16x32_bf16 v[84:87], a[52:55], v[28:31], v[84:87]
    v_lshlrev_b32 v118, 16, v215
    v_and_b32 v119, s0, v215
    v_mfma_f32_16x16x32_bf16 v[88:91], a[56:59], v[28:31], v[88:91]
    buffer_load_dwordx4 v[68:71], v1, s[36:39], s96 offen offset:1024 sc1
    v_mov_b32 v8, 0x3f803f80
    v_mfma_f32_16x16x32_bf16 v[92:95], a[60:63], v[28:31], v[92:95]
    v_and_b32 v5, 15, v0
    v_lshlrev_b32 v5, 4, v5
    s_waitcnt vmcnt(9)
    v_mfma_f32_16x16x32_bf16 v[80:83], a[64:67], v[32:35], v[80:83]
    buffer_load_dwordx4 v[72:75], v1, s[36:39], s96 offen offset:2048 sc1
    v_lshrrev_b32 v11, 5, v0
    v_mfma_f32_16x16x32_bf16 v[84:87], a[68:71], v[32:35], v[84:87]
    v_lshl_add_u32 v5, v11, 8, v5
    v_bfe_u32 v11, v0, 4, 1
    v_mfma_f32_16x16x32_bf16 v[88:91], a[72:75], v[32:35], v[88:91]
    buffer_load_dwordx4 v[76:79], v1, s[36:39], s96 offen offset:3072 sc1
    v_lshl_add_u32 v5, v11, 3, v5
    v_mfma_f32_16x16x32_bf16 v[92:95], a[76:79], v[32:35], v[92:95]
    s_lshl_b32 s94, s89, 9
    s_mul_i32 s95, s5, 112
    s_add_u32 s94, s94, s95
    s_waitcnt vmcnt(10)
    v_mfma_f32_16x16x32_bf16 v[80:83], a[80:83], v[36:39], v[80:83]
    s_add_u32 s57, s94, 4096
    v_min_u32 v12, 27, v0
    v_lshlrev_b32 v12, 2, v12
    v_mfma_f32_16x16x32_bf16 v[84:87], a[84:87], v[36:39], v[84:87]
    s_mul_i32 s83, s89, 112
    s_mul_i32 s84, s5, 28
    s_add_u32 s83, s83, s84
    v_mfma_f32_16x16x32_bf16 v[88:91], a[88:91], v[36:39], v[88:91]
    s_lshl_b32 s83, s83, 11
    s_add_u32 s83, s83, 12582912
    s_waitcnt lgkmcnt(5)
    v_lshlrev_b32 v128, 16, v120
    v_mfma_f32_16x16x32_bf16 v[92:95], a[92:95], v[36:39], v[92:95]
    v_and_b32 v129, s0, v120
    v_lshlrev_b32 v130, 16, v121
    s_waitcnt vmcnt(9)
    v_mfma_f32_16x16x32_bf16 v[80:83], a[96:99], v[40:43], v[80:83]
    v_and_b32 v131, s0, v121
    v_lshlrev_b32 v132, 16, v122
    v_mfma_f32_16x16x32_bf16 v[84:87], a[100:103], v[40:43], v[84:87]
    v_and_b32 v133, s0, v122
    v_lshlrev_b32 v134, 16, v123
    v_mfma_f32_16x16x32_bf16 v[88:91], a[104:107], v[40:43], v[88:91]
    v_and_b32 v135, s0, v123
    s_waitcnt lgkmcnt(2)
    v_lshlrev_b32 v136, 16, v124
    v_mfma_f32_16x16x32_bf16 v[92:95], a[108:111], v[40:43], v[92:95]
    v_and_b32 v137, s0, v124
    v_lshlrev_b32 v138, 16, v125
    s_waitcnt vmcnt(8)
    v_mfma_f32_16x16x32_bf16 v[80:83], a[112:115], v[44:47], v[80:83]
    v_and_b32 v139, s0, v125
    v_lshlrev_b32 v140, 16, v126
    v_mfma_f32_16x16x32_bf16 v[84:87], a[116:119], v[44:47], v[84:87]
    v_and_b32 v141, s0, v126
    v_lshlrev_b32 v142, 16, v127
    v_mfma_f32_16x16x32_bf16 v[88:91], a[120:123], v[44:47], v[88:91]
    v_and_b32 v143, s0, v127
    v_lshlrev_b32 v160, 16, v144
    v_mfma_f32_16x16x32_bf16 v[92:95], a[124:127], v[44:47], v[92:95]
    v_and_b32 v161, s0, v144
    v_lshlrev_b32 v162, 16, v145
    s_waitcnt vmcnt(7)
    v_mfma_f32_16x16x32_bf16 v[80:83], a[128:131], v[48:51], v[80:83]
    v_and_b32 v163, s0, v145
    v_lshlrev_b32 v164, 16, v146
    v_mfma_f32_16x16x32_bf16 v[84:87], a[132:135], v[48:51], v[84:87]
    v_and_b32 v165, s0, v146
    v_lshlrev_b32 v166, 16, v147
    v_mfma_f32_16x16x32_bf16 v[88:91], a[136:139], v[48:51], v[88:91]
    v_and_b32 v167, s0, v147
    s_waitcnt lgkmcnt(1)
    v_lshlrev_b32 v168, 16, v148
    v_mfma_f32_16x16x32_bf16 v[92:95], a[140:143], v[48:51], v[92:95]
    v_and_b32 v169, s0, v148
    v_lshlrev_b32 v170, 16, v149
    s_waitcnt vmcnt(6)
    v_mfma_f32_16x16x32_bf16 v[80:83], a[144:147], v[52:55], v[80:83]
    v_and_b32 v171, s0, v149
    v_lshlrev_b32 v172, 16, v150
    v_mfma_f32_16x16x32_bf16 v[84:87], a[148:151], v[52:55], v[84:87]
    v_and_b32 v173, s0, v150
    v_lshlrev_b32 v174, 16, v151
    v_mfma_f32_16x16x32_bf16 v[88:91], a[152:155], v[52:55], v[88:91]
    v_and_b32 v175, s0, v151
    s_add_u32 s92, s5, 12
    v_mfma_f32_16x16x32_bf16 v[92:95], a[156:159], v[52:55], v[92:95]
    s_mul_i32 s93, s92, 7168
    s_mul_i32 s92, s92, 114688
    s_add_u32 m0, s93, 37376
    s_waitcnt vmcnt(5)
    v_mfma_f32_16x16x32_bf16 v[80:83], a[160:163], v[56:59], v[80:83]
    buffer_load_dwordx4 v224, s[20:23], s92 offen offset:0 lds
    buffer_load_dwordx4 v225, s[20:23], s92 offen offset:1024 lds
    v_mfma_f32_16x16x32_bf16 v[84:87], a[164:167], v[56:59], v[84:87]
    buffer_load_dwordx4 v226, s[20:23], s92 offen offset:2048 lds
    buffer_load_dwordx4 v227, s[20:23], s92 offen offset:3072 lds
    v_mfma_f32_16x16x32_bf16 v[88:91], a[168:171], v[56:59], v[88:91]
    s_add_u32 m0, s93, 41472
    v_mfma_f32_16x16x32_bf16 v[92:95], a[172:175], v[56:59], v[92:95]
    buffer_load_dwordx4 v228, s[20:23], s92 offen offset:0 lds
    buffer_load_dwordx4 v229, s[20:23], s92 offen offset:1024 lds
    s_waitcnt vmcnt(10)
    v_mfma_f32_16x16x32_bf16 v[80:83], a[176:179], v[60:63], v[80:83]
    buffer_load_dwordx4 v230, s[20:23], s92 offen offset:2048 lds
    buffer_load_dword v13, v12, s[36:39], s57 offen sc1
    v_mfma_f32_16x16x32_bf16 v[84:87], a[180:183], v[60:63], v[84:87]
    v_mfma_f32_16x16x32_bf16 v[88:91], a[184:187], v[60:63], v[88:91]
    v_mfma_f32_16x16x32_bf16 v[92:95], a[188:191], v[60:63], v[92:95]
    s_waitcnt vmcnt(11)
    v_mfma_f32_16x16x32_bf16 v[80:83], a[192:195], v[64:67], v[80:83]
    v_mfma_f32_16x16x32_bf16 v[84:87], a[196:199], v[64:67], v[84:87]
    v_mfma_f32_16x16x32_bf16 v[88:91], a[200:203], v[64:67], v[88:91]
    v_mfma_f32_16x16x32_bf16 v[92:95], a[204:207], v[64:67], v[92:95]
    s_waitcnt vmcnt(10)
    v_mfma_f32_16x16x32_bf16 v[80:83], a[208:211], v[68:71], v[80:83]
    v_mfma_f32_16x16x32_bf16 v[84:87], a[212:215], v[68:71], v[84:87]
    v_mfma_f32_16x16x32_bf16 v[88:91], a[216:219], v[68:71], v[88:91]
    v_mfma_f32_16x16x32_bf16 v[92:95], a[220:223], v[68:71], v[92:95]
    s_waitcnt vmcnt(9)
    v_mfma_f32_16x16x32_bf16 v[80:83], a[224:227], v[72:75], v[80:83]
    v_mfma_f32_16x16x32_bf16 v[84:87], a[228:231], v[72:75], v[84:87]
    v_mfma_f32_16x16x32_bf16 v[88:91], a[232:235], v[72:75], v[88:91]
    v_mfma_f32_16x16x32_bf16 v[92:95], a[236:239], v[72:75], v[92:95]
    s_waitcnt vmcnt(8)
    v_mfma_f32_16x16x32_bf16 v[80:83], a[240:243], v[76:79], v[80:83]
    v_mfma_f32_16x16x32_bf16 v[84:87], a[244:247], v[76:79], v[84:87]
    v_mfma_f32_16x16x32_bf16 v[88:91], a[248:251], v[76:79], v[88:91]
    v_mfma_f32_16x16x32_bf16 v[92:95], a[252:255], v[76:79], v[92:95]
    s_lshl_b32 s94, s97, 14
    s_lshl_b32 s95, s89, 11
    s_add_u32 s94, s94, s95
    s_add_u32 s94, s94, 3145728
    s_nop 0
    v_pk_fma_f32 v[104:105], v[80:81], v[128:129], v[104:105]
    v_pk_fma_f32 v[106:107], v[82:83], v[130:131], v[106:107]
    v_pk_fma_f32 v[108:109], v[84:85], v[132:133], v[108:109]
    v_pk_fma_f32 v[110:111], v[86:87], v[134:135], v[110:111]
    v_pk_fma_f32 v[112:113], v[88:89], v[136:137], v[112:113]
    v_pk_fma_f32 v[114:115], v[90:91], v[138:139], v[114:115]
    v_pk_fma_f32 v[116:117], v[92:93], v[140:141], v[116:117]
    v_pk_fma_f32 v[118:119], v[94:95], v[142:143], v[118:119]
    v_cvt_pk_bf16_f32 v232, v104, v105
    v_cvt_pk_bf16_f32 v233, v106, v107
    v_cvt_pk_bf16_f32 v234, v108, v109
    v_cvt_pk_bf16_f32 v235, v110, v111
    v_cvt_pk_bf16_f32 v236, v112, v113
    v_cvt_pk_bf16_f32 v237, v114, v115
    v_cvt_pk_bf16_f32 v238, v116, v117
    v_cvt_pk_bf16_f32 v239, v118, v119
    v_lshlrev_b32 v104, 16, v232
    v_and_b32 v105, s0, v232
    v_lshlrev_b32 v106, 16, v233
    v_and_b32 v107, s0, v233
    v_lshlrev_b32 v108, 16, v234
    v_and_b32 v109, s0, v234
    v_lshlrev_b32 v110, 16, v235
    v_and_b32 v111, s0, v235
    v_lshlrev_b32 v112, 16, v236
    v_and_b32 v113, s0, v236
    v_lshlrev_b32 v114, 16, v237
    v_and_b32 v115, s0, v237
    v_lshlrev_b32 v116, 16, v238
    v_and_b32 v117, s0, v238
    v_lshlrev_b32 v118, 16, v239
    v_and_b32 v119, s0, v239
    v_pk_mul_f32 v[176:177], v[104:105], v[160:161]
    v_pk_mul_f32 v[178:179], v[106:107], v[162:163]
    v_pk_mul_f32 v[180:181], v[108:109], v[164:165]
    v_pk_mul_f32 v[182:183], v[110:111], v[166:167]
    v_pk_mul_f32 v[184:185], v[112:113], v[168:169]
    v_pk_mul_f32 v[186:187], v[114:115], v[170:171]
    v_pk_mul_f32 v[188:189], v[116:117], v[172:173]
    v_pk_mul_f32 v[190:191], v[118:119], v[174:175]
    v_cvt_pk_bf16_f32 v192, v176, v177
    v_cvt_pk_bf16_f32 v193, v178, v179
    v_cvt_pk_bf16_f32 v194, v180, v181
    v_cvt_pk_bf16_f32 v195, v182, v183
    v_cvt_pk_bf16_f32 v196, v184, v185
    v_cvt_pk_bf16_f32 v197, v186, v187
    v_cvt_pk_bf16_f32 v198, v188, v189
    v_cvt_pk_bf16_f32 v199, v190, v191
    buffer_store_dwordx4 v[192:195], v1, s[36:39], s94 offen offset:0 sc1
    buffer_store_dwordx4 v[196:199], v1, s[36:39], s94 offen offset:1024 sc1
    v_dot2_f32_bf16 v200, v232, v8, 0
    v_dot2_f32_bf16 v201, v232, v232, 0
    v_dot2_f32_bf16 v202, v192, v8, 0
    v_dot2_f32_bf16 v203, v192, v144, 0
    v_dot2_f32_bf16 v204, v192, v192, 0
    v_dot2_f32_bf16 v205, v192, v152, 0
    v_dot2_f32_bf16 v200, v233, v8, v200
    v_dot2_f32_bf16 v201, v233, v233, v201
    v_dot2_f32_bf16 v202, v193, v8, v202
    v_dot2_f32_bf16 v203, v193, v145, v203
    v_dot2_f32_bf16 v204, v193, v193, v204
    v_dot2_f32_bf16 v205, v193, v153, v205
    v_dot2_f32_bf16 v200, v234, v8, v200
    v_dot2_f32_bf16 v201, v234, v234, v201
    v_dot2_f32_bf16 v202, v194, v8, v202
    v_dot2_f32_bf16 v203, v194, v146, v203
    v_dot2_f32_bf16 v204, v194, v194, v204
    v_dot2_f32_bf16 v205, v194, v154, v205
    v_dot2_f32_bf16 v200, v235, v8, v200
    v_dot2_f32_bf16 v201, v235, v235, v201
    v_dot2_f32_bf16 v202, v195, v8, v202
    v_dot2_f32_bf16 v203, v195, v147, v203
    v_dot2_f32_bf16 v204, v195, v195, v204
    v_dot2_f32_bf16 v205, v195, v155, v205
    v_dot2_f32_bf16 v200, v236, v8, v200
    v_dot2_f32_bf16 v201, v236, v236, v201
    v_dot2_f32_bf16 v202, v196, v8, v202
    v_dot2_f32_bf16 v203, v196, v148, v203
    v_dot2_f32_bf16 v204, v196, v196, v204
    s_waitcnt lgkmcnt(0)
    v_dot2_f32_bf16 v205, v196, v156, v205
    v_dot2_f32_bf16 v200, v237, v8, v200
    v_dot2_f32_bf16 v201, v237, v237, v201
    v_dot2_f32_bf16 v202, v197, v8, v202
    v_dot2_f32_bf16 v203, v197, v149, v203
    v_dot2_f32_bf16 v204, v197, v197, v204
    v_dot2_f32_bf16 v205, v197, v157, v205
    v_dot2_f32_bf16 v200, v238, v8, v200
    v_dot2_f32_bf16 v201, v238, v238, v201
    v_dot2_f32_bf16 v202, v198, v8, v202
    v_dot2_f32_bf16 v203, v198, v150, v203
    v_dot2_f32_bf16 v204, v198, v198, v204
    v_dot2_f32_bf16 v205, v198, v158, v205
    v_dot2_f32_bf16 v200, v239, v8, v200
    v_dot2_f32_bf16 v201, v239, v239, v201
    v_dot2_f32_bf16 v202, v199, v8, v202
    v_dot2_f32_bf16 v203, v199, v151, v203
    v_dot2_f32_bf16 v204, v199, v199, v204
    v_dot2_f32_bf16 v205, v199, v159, v205
    s_lshl_b32 s95, s97, 3
    s_add_u32 s95, s95, s89
    s_lshl_b32 s94, s95, 9
    s_add_u32 s94, s94, 65536
    v_permlane32_swap_b32 v200, v201
    v_permlane32_swap_b32 v202, v203
    v_permlane32_swap_b32 v204, v205
    v_add_f32 v200, v200, v201
    v_add_f32 v202, v202, v203
    v_add_f32 v204, v204, v205
    v_mov_b32 v205, v204
    v_permlane16_swap_b32 v200, v202
    s_nop 0
    v_permlane16_swap_b32 v204, v205
    v_add_f32 v200, v200, v202
    v_add_f32 v201, v204, v205
    buffer_store_dwordx2 v[200:201], v5, s[36:39], s94 offen sc1
    s_lshl_b32 s94, s95, 2
    s_add_u32 s94, s94, 36864
    s_add_u32 s92, s5, 0
    s_mul_i32 s93, s92, 7168
    s_mul_i32 s92, s92, 114688
    s_add_u32 m0, s93, 37376
    s_nop 0
    buffer_load_dwordx4 v224, s[20:23], s92 offen offset:0 lds
    buffer_load_dwordx4 v225, s[20:23], s92 offen offset:1024 lds
    buffer_load_dwordx4 v226, s[20:23], s92 offen offset:2048 lds
    buffer_load_dwordx4 v227, s[20:23], s92 offen offset:3072 lds
    s_add_u32 m0, s93, 41472
    s_nop 0
    buffer_load_dwordx4 v228, s[20:23], s92 offen offset:0 lds
    buffer_load_dwordx4 v229, s[20:23], s92 offen offset:1024 lds
    buffer_load_dwordx4 v230, s[20:23], s92 offen offset:2048 lds
    s_mul_i32 s95, s5, 2304
    s_add_u32 s95, s95, 8192
    v_and_b32 v9, 15, v0
    v_mul_u32_u24 v9, 144, v9
    v_lshrrev_b32 v10, 4, v0
    v_lshl_add_u32 v9, v10, 4, v9
    v_add_u32 v9, s95, v9
    ds_write_b128 v9, v[232:235] offset:0
    ds_write_b128 v9, v[236:239] offset:64
    s_and_b32 s95, s5, 1
    s_lshl_b32 s95, s95, 10
    v_add_u32 v248, s95, v1
    s_xor_b32 s95, s95, 1024
    v_add_u32 v249, s95, v1
    s_lshl_b32 s92, s89, 7
    s_and_b32 s95, s5, 1
    s_lshl_b32 s95, s95, 6
    s_add_u32 s92, s92, s95
    v_lshrrev_b32 v9, 5, v0
    v_lshl_add_u32 v2, v9, 3, s92
    v_lshrrev_b32 v9, 5, v0
    v_bfe_u32 v10, v0, 4, 1
    v_lshlrev_b32 v9, 4, v9
    v_lshl_add_u32 v9, v10, 2, v9
    v_bfe_u32 v10, v0, 2, 2
    v_add_u32 v9, v9, v10
    s_movk_i32 s95, 224
    v_and_b32 v10, 3, v0
    v_lshlrev_b32 v10, 3, v10
    v_mad_u32_u24 v9, v9, s95, v10
    v_add_u32 v3, 37376, v9
    v_add_u32 v4, 94720, v9
    v_and_b32 v9, 3, v0
    v_mov_b32 v10, 156672
    v_mov_b32 v11, 161792
    v_cmp_eq_u32 vcc, 0, v9
    s_nop 1
    v_cndmask_b32 v10, v10, v11, vcc
    v_mov_b32 v11, 160768
    v_cmp_eq_u32 vcc, 1, v9
    s_nop 1
    v_cndmask_b32 v10, v10, v11, vcc
    v_lshrrev_b32 v9, 4, v0
    v_lshl_add_u32 v5, v9, 4, v10
    s_lshl_b32 s95, s5, 5
    v_add_u32 v6, s95, v3
    v_add_u32 v7, s95, v4
    ds_read_b128 v[16:19], v5 offset:0
    ds_read_b128 v[20:23], v5 offset:64
    ds_read_b128 v[24:27], v5 offset:128
    ds_read_b128 v[28:31], v5 offset:192
    ds_read_b128 v[32:35], v5 offset:256
    ds_read_b128 v[36:39], v5 offset:320
    ds_read_b128 v[40:43], v5 offset:384
    ds_read_b128 v[44:47], v5 offset:448
    ds_read_b128 v[48:51], v5 offset:512
    ds_read_b128 v[52:55], v5 offset:576
    ds_read_b128 v[56:59], v5 offset:640
    ds_read_b128 v[60:63], v5 offset:704
    ds_read_b128 v[64:67], v5 offset:768
    ds_read_b128 v[68:71], v5 offset:832
    ds_read_b128 v[72:75], v5 offset:896
    ds_read_b128 v[76:79], v5 offset:960
    s_waitcnt lgkmcnt(15)
    v_mfma_f32_16x16x32_bf16 v[88:91], v[16:19], v[16:19], 0
    s_waitcnt lgkmcnt(14)
    v_mfma_f32_16x16x32_bf16 v[88:91], v[20:23], v[20:23], v[88:91]
    s_waitcnt lgkmcnt(13)
    v_mfma_f32_16x16x32_bf16 v[88:91], v[24:27], v[24:27], v[88:91]
    s_waitcnt lgkmcnt(12)
    v_mfma_f32_16x16x32_bf16 v[88:91], v[28:31], v[28:31], v[88:91]
    s_waitcnt lgkmcnt(11)
    v_mfma_f32_16x16x32_bf16 v[88:91], v[32:35], v[32:35], v[88:91]
    s_waitcnt lgkmcnt(10)
    v_mfma_f32_16x16x32_bf16 v[88:91], v[36:39], v[36:39], v[88:91]
    s_waitcnt lgkmcnt(9)
    v_mfma_f32_16x16x32_bf16 v[88:91], v[40:43], v[40:43], v[88:91]
    s_waitcnt lgkmcnt(8)
    v_mfma_f32_16x16x32_bf16 v[88:91], v[44:47], v[44:47], v[88:91]
    s_waitcnt lgkmcnt(7)
    v_mfma_f32_16x16x32_bf16 v[88:91], v[48:51], v[48:51], v[88:91]
    s_waitcnt lgkmcnt(6)
    v_mfma_f32_16x16x32_bf16 v[88:91], v[52:55], v[52:55], v[88:91]
    s_waitcnt lgkmcnt(5)
    v_mfma_f32_16x16x32_bf16 v[88:91], v[56:59], v[56:59], v[88:91]
    s_waitcnt lgkmcnt(4)
    v_mfma_f32_16x16x32_bf16 v[88:91], v[60:63], v[60:63], v[88:91]
    s_waitcnt lgkmcnt(3)
    v_mfma_f32_16x16x32_bf16 v[88:91], v[64:67], v[64:67], v[88:91]
    s_waitcnt lgkmcnt(2)
    v_mfma_f32_16x16x32_bf16 v[88:91], v[68:71], v[68:71], v[88:91]
    s_waitcnt lgkmcnt(1)
    v_mfma_f32_16x16x32_bf16 v[88:91], v[72:75], v[72:75], v[88:91]
    s_waitcnt lgkmcnt(0)
    v_mfma_f32_16x16x32_bf16 v[88:91], v[76:79], v[76:79], v[88:91]
    s_mov_b32 s60, 0xffff0000
    s_mov_b32 s61, 0xffff0000
    s_mov_b32 s62, -1
    s_mov_b32 s63, 0
    s_mov_b32 s64, 0
    s_mov_b32 s65, -1
    s_mov_b64 exec, 1
    s_waitcnt vmcnt(7)
    buffer_store_dword v252, off, s[36:39], s94
    s_sub_u32 s94, s94, 12288
    buffer_store_dword v252, off, s[36:39], s94 sc1
    s_mov_b64 exec, -1
    global_load_dwordx2 v[232:233], v2, s[44:45] offset:0
    global_load_dwordx2 v[234:235], v2, s[44:45] offset:16
    global_load_dwordx2 v[236:237], v2, s[44:45] offset:32
    global_load_dwordx2 v[238:239], v2, s[44:45] offset:48
    s_barrier
    ds_read_b64_tr_b16 a[224:225], v6 offset:28672
    ds_read_b64_tr_b16 a[226:227], v6 offset:30464
    ds_read_b64_tr_b16 a[228:229], v6 offset:28800
    ds_read_b64_tr_b16 a[230:231], v6 offset:30592
    ds_read_b64_tr_b16 a[232:233], v6 offset:35840
    ds_read_b64_tr_b16 a[234:235], v6 offset:37632
    ds_read_b64_tr_b16 a[236:237], v6 offset:35968
    ds_read_b64_tr_b16 a[238:239], v6 offset:37760
    ds_read_b64_tr_b16 a[240:241], v6 offset:43008
    ds_read_b64_tr_b16 a[242:243], v6 offset:44800
    ds_read_b64_tr_b16 a[244:245], v6 offset:43136
    ds_read_b64_tr_b16 a[246:247], v6 offset:44928
    v_cmp_ne_u32 vcc, s6, v13
    s_nop 0
    s_cbranch_vccnz L_spin6
L_back6:
    ds_read_b64_tr_b16 a[248:249], v6 offset:50176
    ds_read_b64_tr_b16 a[250:251], v6 offset:51968
    ds_read_b64_tr_b16 a[252:253], v6 offset:50304
    ds_read_b64_tr_b16 a[254:255], v6 offset:52096
    s_waitcnt lgkmcnt(14)
    v_mfma_f32_16x16x32_bf16 v[80:83], v[32:35], a[224:227], 0
    buffer_load_dwordx4 a[0:3], v248, s[36:39], s83 offen offset:0 sc1
    s_waitcnt lgkmcnt(12)
    v_mfma_f32_16x16x32_bf16 v[84:87], v[32:35], a[228:231], 0
    buffer_load_dwordx4 a[4:7], v249, s[36:39], s83 offen offset:0 sc1
    ds_read_b64_tr_b16 a[224:225], v7 offset:0
    ds_read_b64_tr_b16 a[226:227], v7 offset:1792
    ds_read_b64_tr_b16 a[228:229], v7 offset:128
    ds_read_b64_tr_b16 a[230:231], v7 offset:1920
    s_waitcnt lgkmcnt(14)
    v_mfma_f32_16x16x32_bf16 v[80:83], v[36:39], a[232:235], v[80:83]
    s_waitcnt lgkmcnt(12)
    v_mfma_f32_16x16x32_bf16 v[84:87], v[36:39], a[236:239], v[84:87]
    buffer_load_dwordx4 a[8:11], v248, s[36:39], s83 offen offset:2048 sc1
    ds_read_b64_tr_b16 a[232:233], v7 offset:7168
    ds_read_b64_tr_b16 a[234:235], v7 offset:8960
    ds_read_b64_tr_b16 a[236:237], v7 offset:7296
    ds_read_b64_tr_b16 a[238:239], v7 offset:9088
    s_waitcnt lgkmcnt(14)
    v_mfma_f32_16x16x32_bf16 v[80:83], v[40:43], a[240:243], v[80:83]
    buffer_load_dwordx4 a[12:15], v249, s[36:39], s83 offen offset:2048 sc1
    s_waitcnt lgkmcnt(12)
    v_mfma_f32_16x16x32_bf16 v[84:87], v[40:43], a[244:247], v[84:87]
    ds_read_b64_tr_b16 a[240:241], v7 offset:14336
    ds_read_b64_tr_b16 a[242:243], v7 offset:16128
    ds_read_b64_tr_b16 a[244:245], v7 offset:14464
    ds_read_b64_tr_b16 a[246:247], v7 offset:16256
    s_waitcnt lgkmcnt(14)
    v_mfma_f32_16x16x32_bf16 v[80:83], v[44:47], a[248:251], v[80:83]
    s_add_u32 s83, s83, 4096
    s_waitcnt lgkmcnt(12)
    v_mfma_f32_16x16x32_bf16 v[84:87], v[44:47], a[252:255], v[84:87]
    ds_read_b64_tr_b16 a[248:249], v7 offset:21504
    ds_read_b64_tr_b16 a[250:251], v7 offset:23296
    ds_read_b64_tr_b16 a[252:253], v7 offset:21632
    ds_read_b64_tr_b16 a[254:255], v7 offset:23424
    s_waitcnt lgkmcnt(14)
    v_mfma_f32_16x16x32_bf16 v[80:83], v[48:51], a[224:227], v[80:83]
    buffer_load_dwordx4 a[16:19], v248, s[36:39], s83 offen offset:0 sc1
    s_waitcnt lgkmcnt(12)
    v_mfma_f32_16x16x32_bf16 v[84:87], v[48:51], a[228:231], v[84:87]
    buffer_load_dwordx4 a[20:23], v249, s[36:39], s83 offen offset:0 sc1
    ds_read_b64_tr_b16 a[224:225], v7 offset:28672
    ds_read_b64_tr_b16 a[226:227], v7 offset:30464
    ds_read_b64_tr_b16 a[228:229], v7 offset:28800
    ds_read_b64_tr_b16 a[230:231], v7 offset:30592
    s_waitcnt lgkmcnt(14)
    v_mfma_f32_16x16x32_bf16 v[80:83], v[52:55], a[232:235], v[80:83]
    s_waitcnt lgkmcnt(12)
    v_mfma_f32_16x16x32_bf16 v[84:87], v[52:55], a[236:239], v[84:87]
    buffer_load_dwordx4 a[24:27], v248, s[36:39], s83 offen offset:2048 sc1
    ds_read_b64_tr_b16 a[232:233], v7 offset:35840
    ds_read_b64_tr_b16 a[234:235], v7 offset:37632
    ds_read_b64_tr_b16 a[236:237], v7 offset:35968
    ds_read_b64_tr_b16 a[238:239], v7 offset:37760
    s_waitcnt lgkmcnt(14)
    v_mfma_f32_16x16x32_bf16 v[80:83], v[56:59], a[240:243], v[80:83]
    buffer_load_dwordx4 a[28:31], v249, s[36:39], s83 offen offset:2048 sc1
    s_waitcnt lgkmcnt(12)
    v_mfma_f32_16x16x32_bf16 v[84:87], v[56:59], a[244:247], v[84:87]
    ds_read_b64_tr_b16 a[240:241], v7 offset:43008
    ds_read_b64_tr_b16 a[242:243], v7 offset:44800
    ds_read_b64_tr_b16 a[244:245], v7 offset:43136
    ds_read_b64_tr_b16 a[246:247], v7 offset:44928
    s_waitcnt lgkmcnt(14)
    v_mfma_f32_16x16x32_bf16 v[80:83], v[60:63], a[248:251], v[80:83]
    s_lshl_b32 s94, s5, 10
    s_waitcnt lgkmcnt(12)
    v_mfma_f32_16x16x32_bf16 v[84:87], v[60:63], a[252:255], v[84:87]
    ds_read_b64_tr_b16 a[248:249], v7 offset:50176
    ds_read_b64_tr_b16 a[250:251], v7 offset:51968
    ds_read_b64_tr_b16 a[252:253], v7 offset:50304
    ds_read_b64_tr_b16 a[254:255], v7 offset:52096
    s_waitcnt lgkmcnt(14)
    v_mfma_f32_16x16x32_bf16 v[80:83], v[64:67], a[224:227], v[80:83]
    s_add_u32 s94, s94, 0
    s_waitcnt lgkmcnt(12)
    v_mfma_f32_16x16x32_bf16 v[84:87], v[64:67], a[228:231], v[84:87]
    v_add_u32 v9, s94, v1
    s_waitcnt vmcnt(14)
    s_barrier
    ds_read_b64_tr_b16 a[224:225], v6 offset:0
    ds_read_b64_tr_b16 a[226:227], v6 offset:1792
    ds_read_b64_tr_b16 a[228:229], v6 offset:128
    ds_read_b64_tr_b16 a[230:231], v6 offset:1920
    s_waitcnt lgkmcnt(14)
    v_mfma_f32_16x16x32_bf16 v[80:83], v[68:71], a[232:235], v[80:83]
    s_waitcnt lgkmcnt(12)
    v_mfma_f32_16x16x32_bf16 v[84:87], v[68:71], a[236:239], v[84:87]
    v_mul_f32 v88, 0x3b000000, v88
    ds_read_b64_tr_b16 a[232:233], v6 offset:7168
    ds_read_b64_tr_b16 a[234:235], v6 offset:8960
    ds_read_b64_tr_b16 a[236:237], v6 offset:7296
    ds_read_b64_tr_b16 a[238:239], v6 offset:9088
    s_waitcnt lgkmcnt(14)
    v_mfma_f32_16x16x32_bf16 v[80:83], v[72:75], a[240:243], v[80:83]
    v_mul_f32 v89, 0x3b000000, v89
    s_waitcnt lgkmcnt(12)
    v_mfma_f32_16x16x32_bf16 v[84:87], v[72:75], a[244:247], v[84:87]
    ds_read_b64_tr_b16 a[240:241], v6 offset:14336
    ds_read_b64_tr_b16 a[242:243], v6 offset:16128
    ds_read_b64_tr_b16 a[244:245], v6 offset:14464
    ds_read_b64_tr_b16 a[246:247], v6 offset:16256
    s_waitcnt lgkmcnt(14)
    v_mfma_f32_16x16x32_bf16 v[80:83], v[76:79], a[248:251], v[80:83]
    v_mul_f32 v90, 0x3b000000, v90
    s_waitcnt lgkmcnt(12)
    v_mfma_f32_16x16x32_bf16 v[84:87], v[76:79], a[252:255], v[84:87]
    ds_read_b64_tr_b16 a[248:249], v6 offset:21504
    ds_read_b64_tr_b16 a[250:251], v6 offset:23296
    ds_read_b64_tr_b16 a[252:253], v6 offset:21632
    ds_read_b64_tr_b16 a[254:255], v6 offset:23424
    s_waitcnt lgkmcnt(14)
    v_mfma_f32_16x16x32_bf16 v[80:83], v[16:19], a[224:227], v[80:83]
    v_readlane_b32 s50, v88, 0
    s_waitcnt lgkmcnt(12)
    v_mfma_f32_16x16x32_bf16 v[84:87], v[16:19], a[228:231], v[84:87]
    v_readlane_b32 s51, v89, 0
    s_waitcnt lgkmcnt(10)
    v_mfma_f32_16x16x32_bf16 v[80:83], v[20:23], a[232:235], v[80:83]
    s_waitcnt lgkmcnt(8)
    v_mfma_f32_16x16x32_bf16 v[84:87], v[20:23], a[236:239], v[84:87]
    v_readlane_b32 s52, v90, 0
    s_waitcnt lgkmcnt(6)
    v_mfma_f32_16x16x32_bf16 v[80:83], v[24:27], a[240:243], v[80:83]
    v_readlane_b32 s53, v89, 1
    s_waitcnt lgkmcnt(4)
    v_mfma_f32_16x16x32_bf16 v[84:87], v[24:27], a[244:247], v[84:87]
    s_waitcnt lgkmcnt(2)
    v_mfma_f32_16x16x32_bf16 v[80:83], v[28:31], a[248:251], v[80:83]
    v_readlane_b32 s54, v90, 1
    s_waitcnt lgkmcnt(0)
    v_mfma_f32_16x16x32_bf16 v[84:87], v[28:31], a[252:255], v[84:87]
    s_nop 4
    v_cvt_pk_bf16_f32 v97, v80, v81
    v_cvt_pk_bf16_f32 v104, v82, v82
    v_lshlrev_b32 v105, 16, v97
    v_and_b32 v106, 0xffff0000, v97
    v_lshlrev_b32 v104, 16, v104
    v_lshlrev_b32 v107, 16, v246
    v_sub_f32 v80, v80, v105
    v_sub_f32 v81, v81, v106
    v_sub_f32 v82, v82, v104
    v_cvt_pk_bf16_f32 v96, v105, v80
    v_cvt_pk_bf16_f32 v98, v81, v106
    v_cvt_pk_bf16_f32 v99, v104, v82
    v_cvt_pk_bf16_f32 v108, v104, v107
    v_cndmask_b32 v96, v96, v108, s[60:61]
    v_cndmask_b32 v97, v97, v246, s[60:61]
    v_cndmask_b32 v98, v98, 0, s[60:61]
    v_cndmask_b32 v99, v99, 0, s[60:61]
    ds_write_b128 v9, v[96:99] offset:0
    v_cvt_pk_bf16_f32 v101, v84, v85
    v_cvt_pk_bf16_f32 v114, v86, v86
    v_lshlrev_b32 v115, 16, v101
    v_and_b32 v116, 0xffff0000, v101
    v_lshlrev_b32 v114, 16, v114
    v_lshlrev_b32 v117, 16, v247
    v_sub_f32 v84, v84, v115
    v_sub_f32 v85, v85, v116
    v_sub_f32 v86, v86, v114
    v_cvt_pk_bf16_f32 v100, v115, v84
    v_cvt_pk_bf16_f32 v102, v85, v116
    v_cvt_pk_bf16_f32 v103, v114, v86
    v_cvt_pk_bf16_f32 v118, v114, v117
    v_cndmask_b32 v100, v100, v118, s[60:61]
    v_cndmask_b32 v101, v101, v247, s[60:61]
    v_cndmask_b32 v102, v102, 0, s[60:61]
    v_cndmask_b32 v103, v103, 0, s[60:61]
    ds_write_b128 v9, v[100:103] offset:4096
    s_lshl_b32 s97, s90, 3
    s_lshl_b32 s95, s5, 1
    s_add_u32 s97, s97, s95
    s_lshl_b32 s94, s97, 5
    s_add_u32 s94, s94, 36864
    v_and_b32 v9, 15, v0
    v_lshlrev_b32 v5, 4, v9
    v_lshlrev_b32 v9, 2, v9
    v_lshrrev_b32 v10, 4, v0
    v_lshl_add_u32 v5, v10, 10, v5
    s_lshl_b32 s85, s97, 14
    s_add_u32 s85, s85, 3145728
    s_add_u32 s86, s85, 16384
    s_lshl_b32 s96, s97, 12
    s_add_u32 s96, s96, 65536
    s_add_u32 s97, s96, 4096
    ds_read_b64_tr_b16 a[224:225], v3 offset:0
    ds_read_b64_tr_b16 a[226:227], v3 offset:1792
    ds_read_b64_tr_b16 a[228:229], v3 offset:32
    ds_read_b64_tr_b16 a[230:231], v3 offset:1824
    ds_read_b64_tr_b16 a[232:233], v3 offset:64
    ds_read_b64_tr_b16 a[234:235], v3 offset:1856
    ds_read_b64_tr_b16 a[236:237], v3 offset:96
    ds_read_b64_tr_b16 a[238:239], v3 offset:1888
    ds_read_b64_tr_b16 a[240:241], v3 offset:128
    ds_read_b64_tr_b16 a[242:243], v3 offset:1920
    ds_read_b64_tr_b16 a[244:245], v3 offset:7168
    ds_read_b64_tr_b16 a[246:247], v3 offset:8960
    ds_read_b64_tr_b16 a[248:249], v3 offset:7200
    ds_read_b64_tr_b16 a[250:251], v3 offset:8992
    buffer_load_dword v10, v9, s[36:39], s94 offen sc1
    s_waitcnt vmcnt(0)
    v_cmp_ne_u32 vcc, s6, v10
    s_nop 0
    s_cbranch_vccnz L_spin3
L_back3:
    buffer_load_dwordx4 v[16:19], v1, s[36:39], s85 offen offset:0 sc1
    buffer_load_dwordx4 v[20:23], v1, s[36:39], s86 offen offset:0 sc1
    buffer_load_dwordx4 v[24:27], v1, s[36:39], s85 offen offset:1024 sc1
    buffer_load_dwordx4 v[28:31], v1, s[36:39], s86 offen offset:1024 sc1
    buffer_load_dwordx4 v[200:203], v5, s[36:39], s96 offen offset:0 sc1
    buffer_load_dwordx4 v[204:207], v5, s[36:39], s96 offen offset:256 sc1
    buffer_load_dwordx4 v[208:211], v5, s[36:39], s96 offen offset:512 sc1
    buffer_load_dwordx4 v[212:215], v5, s[36:39], s96 offen offset:768 sc1
    buffer_load_dwordx4 v[216:219], v5, s[36:39], s97 offen offset:0 sc1
    buffer_load_dwordx4 v[220:223], v5, s[36:39], s97 offen offset:256 sc1
    buffer_load_dwordx4 v[224:227], v5, s[36:39], s97 offen offset:512 sc1
    buffer_load_dwordx4 v[228:231], v5, s[36:39], s97 offen offset:768 sc1
    buffer_load_dwordx4 v[32:35], v1, s[36:39], s85 offen offset:2048 sc1
    buffer_load_dwordx4 v[36:39], v1, s[36:39], s86 offen offset:2048 sc1
    buffer_load_dwordx4 v[40:43], v1, s[36:39], s85 offen offset:3072 sc1
    buffer_load_dwordx4 v[44:47], v1, s[36:39], s86 offen offset:3072 sc1
    s_waitcnt lgkmcnt(14)
    s_barrier
    v_add_u32 v9, 0, v1
    s_waitcnt lgkmcnt(10)
    ds_read_b128 a[196:199], v9 offset:0
    ds_read_b128 a[200:203], v9 offset:1024
    ds_read_b128 a[204:207], v9 offset:2048
    ds_read_b128 a[208:211], v9 offset:3072
    ds_read_b128 a[212:215], v9 offset:4096
    ds_read_b128 a[216:219], v9 offset:5120
    ds_read_b128 a[220:223], v9 offset:6144
    s_lshl_b32 s94, s90, 2
    s_add_u32 s94, s94, s5
    s_mul_i32 s94, s94, 114688
    s_mul_i32 s95, s91, 7168
    s_add_u32 s94, s94, s95
    s_add_u32 s94, s94, 5242880
    s_waitcnt vmcnt(15)
    v_mfma_f32_16x16x32_bf16 v[144:147], a[224:227], v[16:19], 0
    s_add_u32 s85, s85, 4096
    s_add_u32 s86, s86, 4096
    buffer_load_dwordx4 v[48:51], v1, s[36:39], s85 offen offset:0 sc1
    s_waitcnt vmcnt(15)
    v_mfma_f32_16x16x32_bf16 v[148:151], a[224:227], v[20:23], 0
    ds_read_b64_tr_b16 a[252:253], v3 offset:7232
    ds_read_b64_tr_b16 a[254:255], v3 offset:9024
    v_mfma_f32_16x16x32_bf16 v[152:155], a[228:231], v[16:19], 0
    buffer_load_dwordx4 v[52:55], v1, s[36:39], s86 offen offset:0 sc1
    v_mfma_f32_16x16x32_bf16 v[156:159], a[228:231], v[20:23], 0
    s_waitcnt lgkmcnt(15)
    ds_read_b64_tr_b16 a[224:225], v3 offset:7264
    ds_read_b64_tr_b16 a[226:227], v3 offset:9056
    v_mfma_f32_16x16x32_bf16 v[160:163], a[232:235], v[16:19], 0
    v_mfma_f32_16x16x32_bf16 v[164:167], a[232:235], v[20:23], 0
    ds_read_b64_tr_b16 a[228:229], v3 offset:7296
    ds_read_b64_tr_b16 a[230:231], v3 offset:9088
    v_mfma_f32_16x16x32_bf16 v[168:171], a[236:239], v[16:19], 0
    v_mfma_f32_16x16x32_bf16 v[172:175], a[236:239], v[20:23], 0
    s_waitcnt lgkmcnt(15)
    ds_read_b64_tr_b16 a[232:233], v3 offset:14336
    ds_read_b64_tr_b16 a[234:235], v3 offset:16128
    v_mfma_f32_16x16x32_bf16 v[176:179], a[240:243], v[16:19], 0
    v_mfma_f32_16x16x32_bf16 v[180:183], a[240:243], v[20:23], 0
    ds_read_b64_tr_b16 a[236:237], v3 offset:14368
    ds_read_b64_tr_b16 a[238:239], v3 offset:16160
    s_waitcnt vmcnt(15)
    v_mfma_f32_16x16x32_bf16 v[144:147], a[244:247], v[24:27], v[144:147]
    buffer_load_dwordx4 v[56:59], v1, s[36:39], s85 offen offset:1024 sc1
    buffer_load_dwordx4 v[60:63], v1, s[36:39], s86 offen offset:1024 sc1
    s_waitcnt vmcnt(16)
    v_mfma_f32_16x16x32_bf16 v[148:151], a[244:247], v[28:31], v[148:151]
    s_waitcnt lgkmcnt(8)
    ds_read_b64_tr_b16 a[240:241], v3 offset:14400
    ds_read_b64_tr_b16 a[242:243], v3 offset:16192
    v_mfma_f32_16x16x32_bf16 v[152:155], a[248:251], v[24:27], v[152:155]
    s_waitcnt vmcnt(13)
    v_pk_add_f32 v[200:201], v[200:201], v[208:209]
    v_pk_add_f32 v[202:203], v[202:203], v[210:211]
    v_mfma_f32_16x16x32_bf16 v[156:159], a[248:251], v[28:31], v[156:159]
    ds_read_b64_tr_b16 a[244:245], v3 offset:14432
    ds_read_b64_tr_b16 a[246:247], v3 offset:16224
    v_mfma_f32_16x16x32_bf16 v[160:163], a[252:255], v[24:27], v[160:163]
    s_waitcnt vmcnt(12)
    v_pk_add_f32 v[204:205], v[204:205], v[212:213]
    v_pk_add_f32 v[206:207], v[206:207], v[214:215]
    v_mfma_f32_16x16x32_bf16 v[164:167], a[252:255], v[28:31], v[164:167]
    s_waitcnt lgkmcnt(8)
    ds_read_b64_tr_b16 a[248:249], v3 offset:14464
    ds_read_b64_tr_b16 a[250:251], v3 offset:16256
    v_mfma_f32_16x16x32_bf16 v[168:171], a[224:227], v[24:27], v[168:171]
    s_waitcnt vmcnt(9)
    v_pk_add_f32 v[216:217], v[216:217], v[224:225]
    v_pk_add_f32 v[218:219], v[218:219], v[226:227]
    v_mfma_f32_16x16x32_bf16 v[172:175], a[224:227], v[28:31], v[172:175]
    ds_read_b64_tr_b16 a[252:253], v3 offset:21504
    ds_read_b64_tr_b16 a[254:255], v3 offset:23296
    v_mfma_f32_16x16x32_bf16 v[176:179], a[228:231], v[24:27], v[176:179]
    s_waitcnt vmcnt(8)
    v_pk_add_f32 v[220:221], v[220:221], v[228:229]
    v_pk_add_f32 v[222:223], v[222:223], v[230:231]
    v_mfma_f32_16x16x32_bf16 v[180:183], a[228:231], v[28:31], v[180:183]
    s_waitcnt lgkmcnt(8)
    ds_read_b64_tr_b16 a[224:225], v3 offset:21536
    ds_read_b64_tr_b16 a[226:227], v3 offset:23328
    s_waitcnt vmcnt(7)
    v_mfma_f32_16x16x32_bf16 v[144:147], a[232:235], v[32:35], v[144:147]
    buffer_load_dwordx4 v[64:67], v1, s[36:39], s85 offen offset:2048 sc1
    buffer_load_dwordx4 v[68:71], v1, s[36:39], s86 offen offset:2048 sc1
    s_waitcnt vmcnt(8)
    v_mfma_f32_16x16x32_bf16 v[148:151], a[232:235], v[36:39], v[148:151]
    ds_read_b64_tr_b16 a[228:229], v3 offset:21568
    ds_read_b64_tr_b16 a[230:231], v3 offset:23360
    v_mfma_f32_16x16x32_bf16 v[152:155], a[236:239], v[32:35], v[152:155]
    v_permlane32_swap_b32 v200, v216
    v_mfma_f32_16x16x32_bf16 v[156:159], a[236:239], v[36:39], v[156:159]
    s_waitcnt lgkmcnt(8)
    ds_read_b64_tr_b16 a[232:233], v3 offset:21600
    ds_read_b64_tr_b16 a[234:235], v3 offset:23392
    v_mfma_f32_16x16x32_bf16 v[160:163], a[240:243], v[32:35], v[160:163]
    v_permlane32_swap_b32 v201, v217
    v_mfma_f32_16x16x32_bf16 v[164:167], a[240:243], v[36:39], v[164:167]
    ds_read_b64_tr_b16 a[236:237], v3 offset:21632
    ds_read_b64_tr_b16 a[238:239], v3 offset:23424
    v_mfma_f32_16x16x32_bf16 v[168:171], a[244:247], v[32:35], v[168:171]
    v_permlane32_swap_b32 v202, v218
    v_mfma_f32_16x16x32_bf16 v[172:175], a[244:247], v[36:39], v[172:175]
    s_waitcnt lgkmcnt(8)
    ds_read_b64_tr_b16 a[240:241], v3 offset:28672
    ds_read_b64_tr_b16 a[242:243], v3 offset:30464
    v_mfma_f32_16x16x32_bf16 v[176:179], a[248:251], v[32:35], v[176:179]
    v_permlane32_swap_b32 v204, v220
    v_mfma_f32_16x16x32_bf16 v[180:183], a[248:251], v[36:39], v[180:183]
    ds_read_b64_tr_b16 a[244:245], v3 offset:28704
    ds_read_b64_tr_b16 a[246:247], v3 offset:30496
    s_waitcnt vmcnt(7)
    v_mfma_f32_16x16x32_bf16 v[144:147], a[252:255], v[40:43], v[144:147]
    buffer_load_dwordx4 v[72:75], v1, s[36:39], s85 offen offset:3072 sc1
    buffer_load_dwordx4 v[76:79], v1, s[36:39], s86 offen offset:3072 sc1
    s_waitcnt vmcnt(8)
    v_mfma_f32_16x16x32_bf16 v[148:151], a[252:255], v[44:47], v[148:151]
    s_waitcnt lgkmcnt(8)
    ds_read_b64_tr_b16 a[248:249], v3 offset:28736
    ds_read_b64_tr_b16 a[250:251], v3 offset:30528
    v_mfma_f32_16x16x32_bf16 v[152:155], a[224:227], v[40:43], v[152:155]
    v_permlane32_swap_b32 v205, v221
    v_mfma_f32_16x16x32_bf16 v[156:159], a[224:227], v[44:47], v[156:159]
    ds_read_b64_tr_b16 a[252:253], v3 offset:28768
    ds_read_b64_tr_b16 a[254:255], v3 offset:30560
    v_mfma_f32_16x16x32_bf16 v[160:163], a[228:231], v[40:43], v[160:163]
    v_permlane32_swap_b32 v206, v222
    v_mfma_f32_16x16x32_bf16 v[164:167], a[228:231], v[44:47], v[164:167]
    s_waitcnt lgkmcnt(8)
    ds_read_b64_tr_b16 a[224:225], v3 offset:28800
    ds_read_b64_tr_b16 a[226:227], v3 offset:30592
    v_mfma_f32_16x16x32_bf16 v[168:171], a[232:235], v[40:43], v[168:171]
    v_add_f32 v200, v200, v216
    v_add_f32 v201, v201, v217
    v_mfma_f32_16x16x32_bf16 v[172:175], a[232:235], v[44:47], v[172:175]
    ds_read_b64_tr_b16 a[228:229], v3 offset:35840
    ds_read_b64_tr_b16 a[230:231], v3 offset:37632
    v_mfma_f32_16x16x32_bf16 v[176:179], a[236:239], v[40:43], v[176:179]
    v_add_f32 v202, v202, v218
    v_add_f32 v204, v204, v220
    v_mfma_f32_16x16x32_bf16 v[180:183], a[236:239], v[44:47], v[180:183]
    s_waitcnt lgkmcnt(8)
    ds_read_b64_tr_b16 a[232:233], v3 offset:35872
    ds_read_b64_tr_b16 a[234:235], v3 offset:37664
    s_waitcnt vmcnt(7)
    v_mfma_f32_16x16x32_bf16 v[144:147], a[240:243], v[48:51], v[144:147]
    s_add_u32 s85, s85, 4096
    s_add_u32 s86, s86, 4096
    buffer_load_dwordx4 v[80:83], v1, s[36:39], s85 offen offset:0 sc1
    s_waitcnt vmcnt(7)
    v_mfma_f32_16x16x32_bf16 v[148:151], a[240:243], v[52:55], v[148:151]
    ds_read_b64_tr_b16 a[236:237], v3 offset:35904
    ds_read_b64_tr_b16 a[238:239], v3 offset:37696
    v_mfma_f32_16x16x32_bf16 v[152:155], a[244:247], v[48:51], v[152:155]
    buffer_load_dwordx4 v[84:87], v1, s[36:39], s86 offen offset:0 sc1
    v_add_f32 v205, v205, v221
    v_mfma_f32_16x16x32_bf16 v[156:159], a[244:247], v[52:55], v[156:159]
    s_waitcnt lgkmcnt(8)
    ds_read_b64_tr_b16 a[240:241], v3 offset:35936
    ds_read_b64_tr_b16 a[242:243], v3 offset:37728
    v_mfma_f32_16x16x32_bf16 v[160:163], a[248:251], v[48:51], v[160:163]
    v_add_f32 v206, v206, v222
    v_mov_b32 v216, v200
    v_mfma_f32_16x16x32_bf16 v[164:167], a[248:251], v[52:55], v[164:167]
    ds_read_b64_tr_b16 a[244:245], v3 offset:35968
    ds_read_b64_tr_b16 a[246:247], v3 offset:37760
    v_mfma_f32_16x16x32_bf16 v[168:171], a[252:255], v[48:51], v[168:171]
    v_mov_b32 v217, v201
    v_mov_b32 v218, v202
    v_mfma_f32_16x16x32_bf16 v[172:175], a[252:255], v[52:55], v[172:175]
    s_waitcnt lgkmcnt(8)
    ds_read_b64_tr_b16 a[248:249], v3 offset:43008
    ds_read_b64_tr_b16 a[250:251], v3 offset:44800
    v_mfma_f32_16x16x32_bf16 v[176:179], a[224:227], v[48:51], v[176:179]
    v_mov_b32 v220, v204
    v_mov_b32 v221, v205
    v_mfma_f32_16x16x32_bf16 v[180:183], a[224:227], v[52:55], v[180:183]
    ds_read_b64_tr_b16 a[252:253], v3 offset:43040
    ds_read_b64_tr_b16 a[254:255], v3 offset:44832
    s_waitcnt vmcnt(7)
    v_mfma_f32_16x16x32_bf16 v[144:147], a[228:231], v[56:59], v[144:147]
    buffer_load_dwordx4 v[88:91], v1, s[36:39], s85 offen offset:1024 sc1
    buffer_load_dwordx4 v[92:95], v1, s[36:39], s86 offen offset:1024 sc1
    s_waitcnt vmcnt(8)
    v_mfma_f32_16x16x32_bf16 v[148:151], a[228:231], v[60:63], v[148:151]
    s_waitcnt lgkmcnt(8)
    ds_read_b64_tr_b16 a[224:225], v3 offset:43072
    ds_read_b64_tr_b16 a[226:227], v3 offset:44864
    v_mfma_f32_16x16x32_bf16 v[152:155], a[232:235], v[56:59], v[152:155]
    v_mov_b32 v222, v206
    v_mfma_f32_16x16x32_bf16 v[156:159], a[232:235], v[60:63], v[156:159]
    ds_read_b64_tr_b16 a[228:229], v3 offset:43104
    ds_read_b64_tr_b16 a[230:231], v3 offset:44896
    v_mfma_f32_16x16x32_bf16 v[160:163], a[236:239], v[56:59], v[160:163]
    v_permlane16_swap_b32 v200, v216
    v_mfma_f32_16x16x32_bf16 v[164:167], a[236:239], v[60:63], v[164:167]
    s_waitcnt lgkmcnt(8)
    ds_read_b64_tr_b16 a[232:233], v3 offset:43136
    ds_read_b64_tr_b16 a[234:235], v3 offset:44928
    v_mfma_f32_16x16x32_bf16 v[168:171], a[240:243], v[56:59], v[168:171]
    v_permlane16_swap_b32 v201, v217
    v_mfma_f32_16x16x32_bf16 v[172:175], a[240:243], v[60:63], v[172:175]
    ds_read_b64_tr_b16 a[236:237], v3 offset:50176
    ds_read_b64_tr_b16 a[238:239], v3 offset:51968
    v_mfma_f32_16x16x32_bf16 v[176:179], a[244:247], v[56:59], v[176:179]
    v_permlane16_swap_b32 v202, v218
    v_mfma_f32_16x16x32_bf16 v[180:183], a[244:247], v[60:63], v[180:183]
    s_waitcnt lgkmcnt(8)
    ds_read_b64_tr_b16 a[240:241], v3 offset:50208
    ds_read_b64_tr_b16 a[242:243], v3 offset:52000
    s_waitcnt vmcnt(7)
    v_mfma_f32_16x16x32_bf16 v[144:147], a[248:251], v[64:67], v[144:147]
    buffer_load_dwordx4 v[96:99], v1, s[36:39], s85 offen offset:2048 sc1
    buffer_load_dwordx4 v[100:103], v1, s[36:39], s86 offen offset:2048 sc1
    s_waitcnt vmcnt(8)
    v_mfma_f32_16x16x32_bf16 v[148:151], a[248:251], v[68:71], v[148:151]
    ds_read_b64_tr_b16 a[244:245], v3 offset:50240
    ds_read_b64_tr_b16 a[246:247], v3 offset:52032
    v_mfma_f32_16x16x32_bf16 v[152:155], a[252:255], v[64:67], v[152:155]
    v_permlane16_swap_b32 v204, v220
    v_mfma_f32_16x16x32_bf16 v[156:159], a[252:255], v[68:71], v[156:159]
    s_waitcnt lgkmcnt(8)
    ds_read_b64_tr_b16 a[248:249], v3 offset:50272
    ds_read_b64_tr_b16 a[250:251], v3 offset:52064
    v_mfma_f32_16x16x32_bf16 v[160:163], a[224:227], v[64:67], v[160:163]
    v_permlane16_swap_b32 v205, v221
    v_mfma_f32_16x16x32_bf16 v[164:167], a[224:227], v[68:71], v[164:167]
    ds_read_b64_tr_b16 a[252:253], v3 offset:50304
    ds_read_b64_tr_b16 a[254:255], v3 offset:52096
    v_mfma_f32_16x16x32_bf16 v[168:171], a[228:231], v[64:67], v[168:171]
    v_permlane16_swap_b32 v206, v222
    v_mfma_f32_16x16x32_bf16 v[172:175], a[228:231], v[68:71], v[172:175]
    s_waitcnt lgkmcnt(8)
    ds_read_b64_tr_b16 a[224:225], v4 offset:0
    ds_read_b64_tr_b16 a[226:227], v4 offset:1792
    v_mfma_f32_16x16x32_bf16 v[176:179], a[232:235], v[64:67], v[176:179]
    v_add_f32 v200, v200, v216
    v_add_f32 v201, v201, v217
    v_mfma_f32_16x16x32_bf16 v[180:183], a[232:235], v[68:71], v[180:183]
    ds_read_b64_tr_b16 a[228:229], v4 offset:32
    ds_read_b64_tr_b16 a[230:231], v4 offset:1824
    s_waitcnt vmcnt(7)
    v_mfma_f32_16x16x32_bf16 v[144:147], a[236:239], v[72:75], v[144:147]
    buffer_load_dwordx4 v[104:107], v1, s[36:39], s85 offen offset:3072 sc1
    buffer_load_dwordx4 v[108:111], v1, s[36:39], s86 offen offset:3072 sc1
    s_waitcnt vmcnt(8)
    v_mfma_f32_16x16x32_bf16 v[148:151], a[236:239], v[76:79], v[148:151]
    s_waitcnt lgkmcnt(8)
    ds_read_b64_tr_b16 a[232:233], v4 offset:64
    ds_read_b64_tr_b16 a[234:235], v4 offset:1856
    v_mfma_f32_16x16x32_bf16 v[152:155], a[240:243], v[72:75], v[152:155]
    v_add_f32 v202, v202, v218
    v_add_f32 v204, v204, v220
    v_mfma_f32_16x16x32_bf16 v[156:159], a[240:243], v[76:79], v[156:159]
    ds_read_b64_tr_b16 a[236:237], v4 offset:96
    ds_read_b64_tr_b16 a[238:239], v4 offset:1888
    v_mfma_f32_16x16x32_bf16 v[160:163], a[244:247], v[72:75], v[160:163]
    v_add_f32 v205, v205, v221
    v_add_f32 v206, v206, v222
    v_mfma_f32_16x16x32_bf16 v[164:167], a[244:247], v[76:79], v[164:167]
    s_waitcnt lgkmcnt(8)
    ds_read_b64_tr_b16 a[240:241], v4 offset:128
    ds_read_b64_tr_b16 a[242:243], v4 offset:1920
    v_mfma_f32_16x16x32_bf16 v[168:171], a[248:251], v[72:75], v[168:171]
    s_mov_b32 s55, 0x3b000000
    v_mul_f32 v200, s55, v200
    v_mul_f32 v201, s55, v201
    v_mfma_f32_16x16x32_bf16 v[172:175], a[248:251], v[76:79], v[172:175]
    ds_read_b64_tr_b16 a[244:245], v4 offset:7168
    ds_read_b64_tr_b16 a[246:247], v4 offset:8960
    v_mfma_f32_16x16x32_bf16 v[176:179], a[252:255], v[72:75], v[176:179]
    v_mul_f32 v202, s55, v202
    v_mul_f32 v204, s55, v204
    v_mfma_f32_16x16x32_bf16 v[180:183], a[252:255], v[76:79], v[180:183]
    s_waitcnt lgkmcnt(8)
    ds_read_b64_tr_b16 a[248:249], v4 offset:7200
    ds_read_b64_tr_b16 a[250:251], v4 offset:8992
    s_waitcnt vmcnt(7)
    v_mfma_f32_16x16x32_bf16 v[144:147], a[224:227], v[80:83], v[144:147]
    s_add_u32 s85, s85, 4096
    s_add_u32 s86, s86, 4096
    buffer_load_dwordx4 v[112:115], v1, s[36:39], s85 offen offset:0 sc1
    s_waitcnt vmcnt(7)
    v_mfma_f32_16x16x32_bf16 v[148:151], a[224:227], v[84:87], v[148:151]
    ds_read_b64_tr_b16 a[252:253], v4 offset:7232
    ds_read_b64_tr_b16 a[254:255], v4 offset:9024
    v_mfma_f32_16x16x32_bf16 v[152:155], a[228:231], v[80:83], v[152:155]
    buffer_load_dwordx4 v[116:119], v1, s[36:39], s86 offen offset:0 sc1
    v_mul_f32 v205, s55, v205
    v_mfma_f32_16x16x32_bf16 v[156:159], a[228:231], v[84:87], v[156:159]
    s_waitcnt lgkmcnt(8)
    ds_read_b64_tr_b16 a[224:225], v4 offset:7264
    ds_read_b64_tr_b16 a[226:227], v4 offset:9056
    v_mfma_f32_16x16x32_bf16 v[160:163], a[232:235], v[80:83], v[160:163]
    v_mul_f32 v206, s55, v206
    v_mov_b32 v231, 0x3727c5ac
    v_mfma_f32_16x16x32_bf16 v[164:167], a[232:235], v[84:87], v[164:167]
    ds_read_b64_tr_b16 a[228:229], v4 offset:7296
    ds_read_b64_tr_b16 a[230:231], v4 offset:9088
    v_mfma_f32_16x16x32_bf16 v[168:171], a[236:239], v[80:83], v[168:171]
    v_add_f32 v204, v204, v231
    v_fma_f32 v216, -v200, v200, v204
    v_mfma_f32_16x16x32_bf16 v[172:175], a[236:239], v[84:87], v[172:175]
    s_waitcnt lgkmcnt(8)
    ds_read_b64_tr_b16 a[232:233], v4 offset:14336
    ds_read_b64_tr_b16 a[234:235], v4 offset:16128
    v_mfma_f32_16x16x32_bf16 v[176:179], a[240:243], v[80:83], v[176:179]
    v_rsq_f32 v217, v216
    v_mfma_f32_16x16x32_bf16 v[180:183], a[240:243], v[84:87], v[180:183]
    ds_read_b64_tr_b16 a[236:237], v4 offset:14368
    ds_read_b64_tr_b16 a[238:239], v4 offset:16160
    s_waitcnt vmcnt(7)
    v_mfma_f32_16x16x32_bf16 v[144:147], a[244:247], v[88:91], v[144:147]
    buffer_load_dwordx4 v[120:123], v1, s[36:39], s85 offen offset:1024 sc1
    buffer_load_dwordx4 v[124:127], v1, s[36:39], s86 offen offset:1024 sc1
    s_waitcnt vmcnt(8)
    v_mfma_f32_16x16x32_bf16 v[148:151], a[244:247], v[92:95], v[148:151]
    s_waitcnt lgkmcnt(8)
    ds_read_b64_tr_b16 a[240:241], v4 offset:14400
    ds_read_b64_tr_b16 a[242:243], v4 offset:16192
    v_mfma_f32_16x16x32_bf16 v[152:155], a[248:251], v[88:91], v[152:155]
    v_fma_f32 v202, -v200, s52, v202
    v_mul_f32 v218, s50, v200
    v_mfma_f32_16x16x32_bf16 v[156:159], a[248:251], v[92:95], v[156:159]
    ds_read_b64_tr_b16 a[244:245], v4 offset:14432
    ds_read_b64_tr_b16 a[246:247], v4 offset:16224
    v_mfma_f32_16x16x32_bf16 v[160:163], a[252:255], v[88:91], v[160:163]
    v_fma_f32 v218, -2.0, v206, v218
    v_fma_f32 v218, v200, v218, v201
    v_mfma_f32_16x16x32_bf16 v[164:167], a[252:255], v[92:95], v[164:167]
    s_waitcnt lgkmcnt(8)
    ds_read_b64_tr_b16 a[248:249], v4 offset:14464
    ds_read_b64_tr_b16 a[250:251], v4 offset:16256
    v_mfma_f32_16x16x32_bf16 v[168:171], a[224:227], v[88:91], v[168:171]
    v_fma_f32 v205, -v200, s51, v205
    v_mul_f32 v216, v216, v217
    v_mfma_f32_16x16x32_bf16 v[172:175], a[224:227], v[92:95], v[172:175]
    ds_read_b64_tr_b16 a[252:253], v4 offset:21504
    ds_read_b64_tr_b16 a[254:255], v4 offset:23296
    v_mfma_f32_16x16x32_bf16 v[176:179], a[228:231], v[88:91], v[176:179]
    v_fma_f32 v202, v217, v202, s54
    v_mul_f32 v218, v217, v218
    v_mfma_f32_16x16x32_bf16 v[180:183], a[228:231], v[92:95], v[180:183]
    s_waitcnt lgkmcnt(8)
    ds_read_b64_tr_b16 a[224:225], v4 offset:21536
    ds_read_b64_tr_b16 a[226:227], v4 offset:23328
    s_waitcnt vmcnt(7)
    v_mfma_f32_16x16x32_bf16 v[144:147], a[232:235], v[96:99], v[144:147]
    buffer_load_dwordx4 v[128:131], v1, s[36:39], s85 offen offset:2048 sc1
    buffer_load_dwordx4 v[132:135], v1, s[36:39], s86 offen offset:2048 sc1
    s_waitcnt vmcnt(8)
    v_mfma_f32_16x16x32_bf16 v[148:151], a[232:235], v[100:103], v[148:151]
    ds_read_b64_tr_b16 a[228:229], v4 offset:21568
    ds_read_b64_tr_b16 a[230:231], v4 offset:23360
    v_mfma_f32_16x16x32_bf16 v[152:155], a[236:239], v[96:99], v[152:155]
    v_fma_f32 v218, 2.0, v205, v218
    v_fma_f32 v218, v217, v218, s53
    v_mfma_f32_16x16x32_bf16 v[156:159], a[236:239], v[100:103], v[156:159]
    s_waitcnt lgkmcnt(8)
    ds_read_b64_tr_b16 a[232:233], v4 offset:21600
    ds_read_b64_tr_b16 a[234:235], v4 offset:23392
    v_mfma_f32_16x16x32_bf16 v[160:163], a[240:243], v[96:99], v[160:163]
    v_add_f32 v218, v218, v231
    v_fma_f32 v218, -v202, v202, v218
    v_mfma_f32_16x16x32_bf16 v[164:167], a[240:243], v[100:103], v[164:167]
    ds_read_b64_tr_b16 a[236:237], v4 offset:21632
    ds_read_b64_tr_b16 a[238:239], v4 offset:23424
    v_mfma_f32_16x16x32_bf16 v[168:171], a[244:247], v[96:99], v[168:171]
    v_rsq_f32 v219, v218
    v_mfma_f32_16x16x32_bf16 v[172:175], a[244:247], v[100:103], v[172:175]
    s_waitcnt lgkmcnt(8)
    ds_read_b64_tr_b16 a[240:241], v4 offset:28672
    ds_read_b64_tr_b16 a[242:243], v4 offset:30464
    v_mfma_f32_16x16x32_bf16 v[176:179], a[248:251], v[96:99], v[176:179]
    v_mul_f32 v220, -v202, v216
    v_sub_f32 v200, 0, v200
    v_mfma_f32_16x16x32_bf16 v[180:183], a[248:251], v[100:103], v[180:183]
    ds_read_b64_tr_b16 a[244:245], v4 offset:28704
    ds_read_b64_tr_b16 a[246:247], v4 offset:30496
    s_waitcnt vmcnt(7)
    v_mfma_f32_16x16x32_bf16 v[144:147], a[252:255], v[104:107], v[144:147]
    buffer_load_dwordx4 v[136:139], v1, s[36:39], s85 offen offset:3072 sc1
    buffer_load_dwordx4 v[140:143], v1, s[36:39], s86 offen offset:3072 sc1
    s_waitcnt vmcnt(8)
    v_mfma_f32_16x16x32_bf16 v[148:151], a[252:255], v[108:111], v[148:151]
    s_waitcnt lgkmcnt(8)
    ds_read_b64_tr_b16 a[248:249], v4 offset:28736
    ds_read_b64_tr_b16 a[250:251], v4 offset:30528
    v_mfma_f32_16x16x32_bf16 v[152:155], a[224:227], v[104:107], v[152:155]
    v_mul_f32 v218, v218, v219
    v_mul_f32 v219, v217, v219
    v_mfma_f32_16x16x32_bf16 v[156:159], a[224:227], v[108:111], v[156:159]
    ds_read_b64_tr_b16 a[252:253], v4 offset:28768
    ds_read_b64_tr_b16 a[254:255], v4 offset:30560
    v_mfma_f32_16x16x32_bf16 v[160:163], a[228:231], v[104:107], v[160:163]
    v_mul_f32 v244, v216, v218
    v_mul_f32 v240, 0xc0135761, v219
    v_mfma_f32_16x16x32_bf16 v[164:167], a[228:231], v[108:111], v[164:167]
    s_waitcnt lgkmcnt(8)
    ds_read_b64_tr_b16 a[224:225], v4 offset:28800
    ds_read_b64_tr_b16 a[226:227], v4 offset:30592
    v_mfma_f32_16x16x32_bf16 v[168:171], a[232:235], v[104:107], v[168:171]
    v_mul_f32 v221, v219, v219
    v_mul_f32 v221, 0x3d372713, v221
    v_mfma_f32_16x16x32_bf16 v[172:175], a[232:235], v[108:111], v[172:175]
    ds_read_b64_tr_b16 a[228:229], v4 offset:35840
    ds_read_b64_tr_b16 a[230:231], v4 offset:37632
    v_mfma_f32_16x16x32_bf16 v[176:179], a[236:239], v[104:107], v[176:179]
    v_mul_f32 v242, v221, v240
    v_cvt_pk_bf16_f32 v222, v200, v216
    v_mfma_f32_16x16x32_bf16 v[180:183], a[236:239], v[108:111], v[180:183]
    s_waitcnt lgkmcnt(8)
    ds_read_b64_tr_b16 a[232:233], v4 offset:35872
    ds_read_b64_tr_b16 a[234:235], v4 offset:37664
    s_waitcnt vmcnt(7)
    v_mfma_f32_16x16x32_bf16 v[144:147], a[240:243], v[112:115], v[144:147]
    s_lshl_b32 s93, s88, 7
    s_add_u32 s93, s93, 32768
    v_min_u32 v10, 2, v0
    s_waitcnt vmcnt(6)
    v_mfma_f32_16x16x32_bf16 v[148:151], a[240:243], v[116:119], v[148:151]
    ds_read_b64_tr_b16 a[236:237], v4 offset:35904
    ds_read_b64_tr_b16 a[238:239], v4 offset:37696
    v_mfma_f32_16x16x32_bf16 v[152:155], a[244:247], v[112:115], v[152:155]
    v_lshlrev_b32 v10, 12, v10
    v_mfma_f32_16x16x32_bf16 v[156:159], a[244:247], v[116:119], v[156:159]
    s_waitcnt lgkmcnt(8)
    ds_read_b64_tr_b16 a[240:241], v4 offset:35936
    ds_read_b64_tr_b16 a[242:243], v4 offset:37728
    v_mfma_f32_16x16x32_bf16 v[160:163], a[248:251], v[112:115], v[160:163]
    buffer_load_dword v255, v10, s[36:39], s93 offen
    s_add_u32 s83, s83, 4096
    v_mfma_f32_16x16x32_bf16 v[164:167], a[248:251], v[116:119], v[164:167]
    ds_read_b64_tr_b16 a[244:245], v4 offset:35968
    ds_read_b64_tr_b16 a[246:247], v4 offset:37760
    v_mfma_f32_16x16x32_bf16 v[168:171], a[252:255], v[112:115], v[168:171]
    buffer_load_dwordx4 a[32:35], v248, s[36:39], s83 offen offset:0 sc1
    buffer_load_dwordx4 a[36:39], v249, s[36:39], s83 offen offset:0 sc1
    v_mfma_f32_16x16x32_bf16 v[172:175], a[252:255], v[116:119], v[172:175]
    s_waitcnt lgkmcnt(8)
    ds_read_b64_tr_b16 a[248:249], v4 offset:43008
    ds_read_b64_tr_b16 a[250:251], v4 offset:44800
    v_mfma_f32_16x16x32_bf16 v[176:179], a[224:227], v[112:115], v[176:179]
    buffer_load_dwordx4 a[40:43], v248, s[36:39], s83 offen offset:2048 sc1
    buffer_load_dwordx4 a[44:47], v249, s[36:39], s83 offen offset:2048 sc1
    v_mfma_f32_16x16x32_bf16 v[180:183], a[224:227], v[116:119], v[180:183]
    ds_read_b64_tr_b16 a[252:253], v4 offset:43040
    ds_read_b64_tr_b16 a[254:255], v4 offset:44832
    s_waitcnt vmcnt(10)
    v_mfma_f32_16x16x32_bf16 v[144:147], a[228:231], v[120:123], v[144:147]
    s_add_u32 s83, s83, 4096
    buffer_load_dwordx4 a[48:51], v248, s[36:39], s83 offen offset:0 sc1
    buffer_load_dwordx4 a[52:55], v249, s[36:39], s83 offen offset:0 sc1
    s_waitcnt vmcnt(11)
    v_mfma_f32_16x16x32_bf16 v[148:151], a[228:231], v[124:127], v[148:151]
    s_waitcnt lgkmcnt(8)
    ds_read_b64_tr_b16 a[224:225], v4 offset:43072
    ds_read_b64_tr_b16 a[226:227], v4 offset:44864
    v_mfma_f32_16x16x32_bf16 v[152:155], a[232:235], v[120:123], v[152:155]
    buffer_load_dwordx4 a[56:59], v248, s[36:39], s83 offen offset:2048 sc1
    v_cvt_pk_bf16_f32 v223, v220, v244
    v_mfma_f32_16x16x32_bf16 v[156:159], a[232:235], v[124:127], v[156:159]
    ds_read_b64_tr_b16 a[228:229], v4 offset:43104
    ds_read_b64_tr_b16 a[230:231], v4 offset:44896
    v_mfma_f32_16x16x32_bf16 v[160:163], a[236:239], v[120:123], v[160:163]
    v_lshlrev_b32 v224, 16, v222
    v_and_b32 v225, 0xffff0000, v222
    v_mfma_f32_16x16x32_bf16 v[164:167], a[236:239], v[124:127], v[164:167]
    s_waitcnt lgkmcnt(8)
    ds_read_b64_tr_b16 a[232:233], v4 offset:43136
    ds_read_b64_tr_b16 a[234:235], v4 offset:44928
    v_mfma_f32_16x16x32_bf16 v[168:171], a[240:243], v[120:123], v[168:171]
    v_lshlrev_b32 v226, 16, v223
    v_and_b32 v227, 0xffff0000, v223
    v_mfma_f32_16x16x32_bf16 v[172:175], a[240:243], v[124:127], v[172:175]
    ds_read_b64_tr_b16 a[236:237], v4 offset:50176
    ds_read_b64_tr_b16 a[238:239], v4 offset:51968
    v_mfma_f32_16x16x32_bf16 v[176:179], a[244:247], v[120:123], v[176:179]
    v_sub_f32 v200, v200, v224
    v_sub_f32 v216, v216, v225
    v_mfma_f32_16x16x32_bf16 v[180:183], a[244:247], v[124:127], v[180:183]
    s_waitcnt lgkmcnt(8)
    ds_read_b64_tr_b16 a[240:241], v4 offset:50208
    ds_read_b64_tr_b16 a[242:243], v4 offset:52000
    s_waitcnt vmcnt(11)
    v_mfma_f32_16x16x32_bf16 v[144:147], a[248:251], v[128:131], v[144:147]
    buffer_load_dwordx4 a[60:63], v249, s[36:39], s83 offen offset:2048 sc1
    s_add_u32 s83, s83, 4096
    s_waitcnt vmcnt(11)
    v_mfma_f32_16x16x32_bf16 v[148:151], a[248:251], v[132:135], v[148:151]
    ds_read_b64_tr_b16 a[244:245], v4 offset:50240
    ds_read_b64_tr_b16 a[246:247], v4 offset:52032
    v_mfma_f32_16x16x32_bf16 v[152:155], a[252:255], v[128:131], v[152:155]
    buffer_load_dwordx4 a[64:67], v248, s[36:39], s83 offen offset:0 sc1
    buffer_load_dwordx4 a[68:71], v249, s[36:39], s83 offen offset:0 sc1
    v_mfma_f32_16x16x32_bf16 v[156:159], a[252:255], v[132:135], v[156:159]
    s_waitcnt lgkmcnt(8)
    ds_read_b64_tr_b16 a[248:249], v4 offset:50272
    ds_read_b64_tr_b16 a[250:251], v4 offset:52064
    v_mfma_f32_16x16x32_bf16 v[160:163], a[224:227], v[128:131], v[160:163]
    buffer_load_dwordx4 a[72:75], v248, s[36:39], s83 offen offset:2048 sc1
    v_sub_f32 v220, v220, v226
    v_mfma_f32_16x16x32_bf16 v[164:167], a[224:227], v[132:135], v[164:167]
    ds_read_b64_tr_b16 a[252:253], v4 offset:50304
    ds_read_b64_tr_b16 a[254:255], v4 offset:52096
    v_mfma_f32_16x16x32_bf16 v[168:171], a[228:231], v[128:131], v[168:171]
    v_sub_f32 v221, v244, v227
    v_cvt_pk_bf16_f32 v201, v224, v224
    v_mfma_f32_16x16x32_bf16 v[172:175], a[228:231], v[132:135], v[172:175]
    s_waitcnt lgkmcnt(8)
    ds_read_b64_tr_b16 a[224:225], v3 offset:160
    ds_read_b64_tr_b16 a[226:227], v3 offset:1952
    v_mfma_f32_16x16x32_bf16 v[176:179], a[232:235], v[128:131], v[176:179]
    v_cvt_pk_bf16_f32 v202, v200, v225
    v_cvt_pk_bf16_f32 v203, v225, v216
    v_mfma_f32_16x16x32_bf16 v[180:183], a[232:235], v[132:135], v[180:183]
    ds_read_b64_tr_b16 a[228:229], v3 offset:192
    ds_read_b64_tr_b16 a[230:231], v3 offset:1984
    s_waitcnt vmcnt(13)
    v_mfma_f32_16x16x32_bf16 v[144:147], a[236:239], v[136:139], v[144:147]
    buffer_load_dwordx4 a[76:79], v249, s[36:39], s83 offen offset:2048 sc1
    s_add_u32 s83, s83, 4096
    s_waitcnt vmcnt(13)
    v_mfma_f32_16x16x32_bf16 v[148:151], a[236:239], v[140:143], v[148:151]
    s_waitcnt lgkmcnt(8)
    ds_read_b64_tr_b16 a[232:233], v3 offset:7328
    ds_read_b64_tr_b16 a[234:235], v3 offset:9120
    v_mfma_f32_16x16x32_bf16 v[152:155], a[240:243], v[136:139], v[152:155]
    buffer_load_dwordx4 a[80:83], v248, s[36:39], s83 offen offset:0 sc1
    buffer_load_dwordx4 a[84:87], v249, s[36:39], s83 offen offset:0 sc1
    v_mfma_f32_16x16x32_bf16 v[156:159], a[240:243], v[140:143], v[156:159]
    ds_read_b64_tr_b16 a[236:237], v3 offset:7360
    ds_read_b64_tr_b16 a[238:239], v3 offset:9152
    v_mfma_f32_16x16x32_bf16 v[160:163], a[244:247], v[136:139], v[160:163]
    v_cvt_pk_bf16_f32 v204, v226, v226
    v_cvt_pk_bf16_f32 v228, v220, v227
    v_mfma_f32_16x16x32_bf16 v[164:167], a[244:247], v[140:143], v[164:167]
    s_waitcnt lgkmcnt(8)
    ds_read_b64_tr_b16 a[240:241], v3 offset:14496
    ds_read_b64_tr_b16 a[242:243], v3 offset:16288
    v_mfma_f32_16x16x32_bf16 v[168:171], a[248:251], v[136:139], v[168:171]
    v_cvt_pk_bf16_f32 v229, v221, 0
    v_cndmask_b32 v201, v201, v228, s[60:61]
    v_mfma_f32_16x16x32_bf16 v[172:175], a[248:251], v[140:143], v[172:175]
    ds_read_b64_tr_b16 a[244:245], v3 offset:14528
    ds_read_b64_tr_b16 a[246:247], v3 offset:16320
    v_mfma_f32_16x16x32_bf16 v[176:179], a[252:255], v[136:139], v[176:179]
    v_cndmask_b32 v202, v202, v229, s[60:61]
    v_cndmask_b32 v203, v203, 0, s[60:61]
    v_mfma_f32_16x16x32_bf16 v[180:183], a[252:255], v[140:143], v[180:183]
    s_waitcnt lgkmcnt(8)
    ds_read_b64_tr_b16 a[248:249], v3 offset:21664
    ds_read_b64_tr_b16 a[250:251], v3 offset:23456
    v_cndmask_b32 v204, v204, 0, s[60:61]
    v_cndmask_b32 v208, 0, v201, s[62:63]
    v_cndmask_b32 v212, 0, v201, s[64:65]
    v_cndmask_b32 v209, 0, v202, s[62:63]
    v_cndmask_b32 v213, 0, v202, s[64:65]
    v_cndmask_b32 v210, 0, v203, s[62:63]
    v_cndmask_b32 v214, 0, v203, s[64:65]
    v_cndmask_b32 v211, 0, v204, s[62:63]
    v_cndmask_b32 v215, 0, v204, s[64:65]
    v_mov_b32 v246, v240
    v_mov_b32 v250, v242
    v_mov_b32 v6, v244
    v_permlane32_swap_b32 v240, v246
    v_permlane32_swap_b32 v242, v250
    v_permlane32_swap_b32 v244, v6
    v_mfma_f32_16x16x32_bf16 v[144:147], a[196:199], v[208:211], v[144:147]
    v_mfma_f32_16x16x32_bf16 v[148:151], a[196:199], v[212:215], v[148:151]
    v_mfma_f32_16x16x32_bf16 v[152:155], a[200:203], v[208:211], v[152:155]
    v_mfma_f32_16x16x32_bf16 v[156:159], a[200:203], v[212:215], v[156:159]
    v_mfma_f32_16x16x32_bf16 v[160:163], a[204:207], v[208:211], v[160:163]
    v_mfma_f32_16x16x32_bf16 v[164:167], a[204:207], v[212:215], v[164:167]
    v_mfma_f32_16x16x32_bf16 v[168:171], a[208:211], v[208:211], v[168:171]
    v_mfma_f32_16x16x32_bf16 v[172:175], a[208:211], v[212:215], v[172:175]
    v_mfma_f32_16x16x32_bf16 v[176:179], a[212:215], v[208:211], v[176:179]
    v_pk_mul_f32 v[216:217], v[144:145], v[144:145]
    buffer_load_dwordx4 a[88:91], v248, s[36:39], s83 offen offset:2048 sc1
    v_pk_mul_f32 v[218:219], v[146:147], v[146:147]
    v_pk_mul_f32 v[220:221], v[148:149], v[148:149]
    v_pk_mul_f32 v[222:223], v[150:151], v[150:151]
    v_mfma_f32_16x16x32_bf16 v[180:183], a[212:215], v[212:215], v[180:183]
    v_pk_fma_f32 v[216:217], v[216:217], v[242:243], v[240:241] op_sel_hi:[1,0,0]
    v_pk_fma_f32 v[218:219], v[218:219], v[242:243], v[240:241] op_sel_hi:[1,0,0]
    v_pk_fma_f32 v[220:221], v[220:221], v[250:251], v[246:247] op_sel_hi:[1,0,0]
    v_pk_fma_f32 v[222:223], v[222:223], v[250:251], v[246:247] op_sel_hi:[1,0,0]
    buffer_load_dwordx4 a[92:95], v249, s[36:39], s83 offen offset:2048 sc1
    v_mfma_f32_16x16x32_bf16 v[184:187], a[224:227], v[16:19], 0
    v_pk_mul_f32 v[216:217], v[216:217], v[144:145]
    v_pk_mul_f32 v[218:219], v[218:219], v[146:147]
    v_pk_mul_f32 v[220:221], v[220:221], v[148:149]
    v_pk_mul_f32 v[222:223], v[222:223], v[150:151]
    v_exp_f32 v216, v216
    v_mfma_f32_16x16x32_bf16 v[188:191], a[224:227], v[20:23], 0
    ds_read_b64_tr_b16 a[252:253], v3 offset:21696
    ds_read_b64_tr_b16 a[254:255], v3 offset:23488
    v_exp_f32 v217, v217
    v_exp_f32 v218, v218
    s_add_u32 s83, s83, 4096
    v_mfma_f32_16x16x32_bf16 v[192:195], a[228:231], v[16:19], 0
    v_exp_f32 v219, v219
    v_exp_f32 v220, v220
    v_exp_f32 v221, v221
    v_exp_f32 v222, v222
    v_mfma_f32_16x16x32_bf16 v[196:199], a[228:231], v[20:23], 0
    s_waitcnt lgkmcnt(8)
    ds_read_b64_tr_b16 a[224:225], v3 offset:28832
    ds_read_b64_tr_b16 a[226:227], v3 offset:30624
    v_exp_f32 v223, v223
    v_pk_fma_f32 v[216:217], v[216:217], v[244:245], v[244:245] op_sel_hi:[1,0,0]
    v_pk_fma_f32 v[218:219], v[218:219], v[244:245], v[244:245] op_sel_hi:[1,0,0]
    v_mfma_f32_16x16x32_bf16 v[184:187], a[232:235], v[24:27], v[184:187]
    buffer_load_dwordx4 a[96:99], v248, s[36:39], s83 offen offset:0 sc1
    v_pk_fma_f32 v[220:221], v[220:221], v[6:7], v[6:7] op_sel_hi:[1,0,0]
    v_pk_fma_f32 v[222:223], v[222:223], v[6:7], v[6:7] op_sel_hi:[1,0,0]
    v_rcp_f32 v216, v216
    v_rcp_f32 v217, v217
    v_mfma_f32_16x16x32_bf16 v[188:191], a[232:235], v[28:31], v[188:191]
    ds_read_b64_tr_b16 a[228:229], v3 offset:28864
    ds_read_b64_tr_b16 a[230:231], v3 offset:30656
    v_rcp_f32 v218, v218
    v_rcp_f32 v219, v219
    v_rcp_f32 v220, v220
    v_mfma_f32_16x16x32_bf16 v[192:195], a[236:239], v[24:27], v[192:195]
    buffer_load_dwordx4 a[100:103], v249, s[36:39], s83 offen offset:0 sc1
    v_rcp_f32 v221, v221
    v_rcp_f32 v222, v222
    v_rcp_f32 v223, v223
    v_pk_mul_f32 v[216:217], v[216:217], v[144:145]
    v_mfma_f32_16x16x32_bf16 v[196:199], a[236:239], v[28:31], v[196:199]
    s_waitcnt lgkmcnt(8)
    ds_read_b64_tr_b16 a[232:233], v3 offset:36000
    ds_read_b64_tr_b16 a[234:235], v3 offset:37792
    v_pk_mul_f32 v[218:219], v[218:219], v[146:147]
    v_pk_mul_f32 v[220:221], v[220:221], v[148:149]
    v_pk_mul_f32 v[222:223], v[222:223], v[150:151]
    buffer_load_dwordx4 a[104:107], v248, s[36:39], s83 offen offset:2048 sc1
    v_mfma_f32_16x16x32_bf16 v[184:187], a[240:243], v[32:35], v[184:187]
    v_cvt_pk_bf16_f32 v144, v216, v217
    v_cvt_pk_bf16_f32 v145, v218, v219
    v_cvt_pk_bf16_f32 v146, v220, v221
    v_cvt_pk_bf16_f32 v147, v222, v223
    v_mfma_f32_16x16x32_bf16 v[188:191], a[240:243], v[36:39], v[188:191]
    ds_read_b64_tr_b16 a[236:237], v3 offset:36032
    ds_read_b64_tr_b16 a[238:239], v3 offset:37824
    v_permlane16_swap_b32 v144, v146
    v_permlane16_swap_b32 v145, v147
    v_mfma_f32_16x16x32_bf16 v[192:195], a[244:247], v[32:35], v[192:195]
    buffer_store_dwordx4 v[144:147], v1, s[36:39], s94 offen offset:0 sc1
    v_pk_mul_f32 v[224:225], v[152:153], v[152:153]
    buffer_load_dwordx4 a[108:111], v249, s[36:39], s83 offen offset:2048 sc1
    v_pk_mul_f32 v[226:227], v[154:155], v[154:155]
    v_pk_mul_f32 v[228:229], v[156:157], v[156:157]
    v_mfma_f32_16x16x32_bf16 v[196:199], a[244:247], v[36:39], v[196:199]
    s_waitcnt lgkmcnt(8)
    ds_read_b64_tr_b16 a[240:241], v3 offset:43168
    ds_read_b64_tr_b16 a[242:243], v3 offset:44960
    v_pk_mul_f32 v[230:231], v[158:159], v[158:159]
    v_pk_fma_f32 v[224:225], v[224:225], v[242:243], v[240:241] op_sel_hi:[1,0,0]
    v_pk_fma_f32 v[226:227], v[226:227], v[242:243], v[240:241] op_sel_hi:[1,0,0]
    v_pk_fma_f32 v[228:229], v[228:229], v[250:251], v[246:247] op_sel_hi:[1,0,0]
    v_pk_fma_f32 v[230:231], v[230:231], v[250:251], v[246:247] op_sel_hi:[1,0,0]
    v_mfma_f32_16x16x32_bf16 v[184:187], a[248:251], v[40:43], v[184:187]
    s_add_u32 s83, s83, 4096
    v_pk_mul_f32 v[224:225], v[224:225], v[152:153]
    v_pk_mul_f32 v[226:227], v[226:227], v[154:155]
    v_pk_mul_f32 v[228:229], v[228:229], v[156:157]
    v_pk_mul_f32 v[230:231], v[230:231], v[158:159]
    v_mfma_f32_16x16x32_bf16 v[188:191], a[248:251], v[44:47], v[188:191]
    ds_read_b64_tr_b16 a[244:245], v3 offset:43200
    ds_read_b64_tr_b16 a[246:247], v3 offset:44992
    v_exp_f32 v224, v224
    v_exp_f32 v225, v225
    v_exp_f32 v226, v226
    v_mfma_f32_16x16x32_bf16 v[192:195], a[252:255], v[40:43], v[192:195]
    buffer_load_dwordx4 a[112:115], v248, s[36:39], s83 offen offset:0 sc1
    v_exp_f32 v227, v227
    v_exp_f32 v228, v228
    v_exp_f32 v229, v229
    v_mfma_f32_16x16x32_bf16 v[196:199], a[252:255], v[44:47], v[196:199]
    s_waitcnt lgkmcnt(8)
    ds_read_b64_tr_b16 a[248:249], v3 offset:50336
    ds_read_b64_tr_b16 a[250:251], v3 offset:52128
    v_exp_f32 v230, v230
    v_exp_f32 v231, v231
    v_pk_fma_f32 v[224:225], v[224:225], v[244:245], v[244:245] op_sel_hi:[1,0,0]
    v_pk_fma_f32 v[226:227], v[226:227], v[244:245], v[244:245] op_sel_hi:[1,0,0]
    v_mfma_f32_16x16x32_bf16 v[184:187], a[224:227], v[48:51], v[184:187]
    buffer_load_dwordx4 a[116:119], v249, s[36:39], s83 offen offset:0 sc1
    v_pk_fma_f32 v[228:229], v[228:229], v[6:7], v[6:7] op_sel_hi:[1,0,0]
    v_pk_fma_f32 v[230:231], v[230:231], v[6:7], v[6:7] op_sel_hi:[1,0,0]
    v_rcp_f32 v224, v224
    v_rcp_f32 v225, v225
    v_mfma_f32_16x16x32_bf16 v[188:191], a[224:227], v[52:55], v[188:191]
    ds_read_b64_tr_b16 a[252:253], v3 offset:50368
    ds_read_b64_tr_b16 a[254:255], v3 offset:52160
    v_rcp_f32 v226, v226
    v_rcp_f32 v227, v227
    v_rcp_f32 v228, v228
    v_mfma_f32_16x16x32_bf16 v[192:195], a[228:231], v[48:51], v[192:195]
    buffer_load_dwordx4 a[120:123], v248, s[36:39], s83 offen offset:2048 sc1
    v_rcp_f32 v229, v229
    v_rcp_f32 v230, v230
    v_rcp_f32 v231, v231
    v_pk_mul_f32 v[224:225], v[224:225], v[152:153]
    v_mfma_f32_16x16x32_bf16 v[196:199], a[228:231], v[52:55], v[196:199]
    s_waitcnt lgkmcnt(8)
    ds_read_b64_tr_b16 a[224:225], v4 offset:160
    ds_read_b64_tr_b16 a[226:227], v4 offset:1952
    v_pk_mul_f32 v[226:227], v[226:227], v[154:155]
    v_pk_mul_f32 v[228:229], v[228:229], v[156:157]
    v_pk_mul_f32 v[230:231], v[230:231], v[158:159]
    buffer_load_dwordx4 a[124:127], v249, s[36:39], s83 offen offset:2048 sc1
    v_mfma_f32_16x16x32_bf16 v[184:187], a[232:235], v[56:59], v[184:187]
    v_cvt_pk_bf16_f32 v152, v224, v225
    v_cvt_pk_bf16_f32 v153, v226, v227
    v_cvt_pk_bf16_f32 v154, v228, v229
    v_cvt_pk_bf16_f32 v155, v230, v231
    v_mfma_f32_16x16x32_bf16 v[188:191], a[232:235], v[60:63], v[188:191]
    ds_read_b64_tr_b16 a[228:229], v4 offset:192
    ds_read_b64_tr_b16 a[230:231], v4 offset:1984
    v_permlane16_swap_b32 v152, v154
    v_permlane16_swap_b32 v153, v155
    v_mfma_f32_16x16x32_bf16 v[192:195], a[236:239], v[56:59], v[192:195]
    buffer_store_dwordx4 v[152:155], v1, s[36:39], s94 offen offset:1024 sc1
    v_pk_mul_f32 v[216:217], v[160:161], v[160:161]
    s_add_u32 s83, s83, 4096
    v_pk_mul_f32 v[218:219], v[162:163], v[162:163]
    v_pk_mul_f32 v[220:221], v[164:165], v[164:165]
    v_mfma_f32_16x16x32_bf16 v[196:199], a[236:239], v[60:63], v[196:199]
    s_waitcnt lgkmcnt(8)
    ds_read_b64_tr_b16 a[232:233], v4 offset:7328
    ds_read_b64_tr_b16 a[234:235], v4 offset:9120
    v_pk_mul_f32 v[222:223], v[166:167], v[166:167]
    v_pk_fma_f32 v[216:217], v[216:217], v[242:243], v[240:241] op_sel_hi:[1,0,0]
    v_pk_fma_f32 v[218:219], v[218:219], v[242:243], v[240:241] op_sel_hi:[1,0,0]
    v_pk_fma_f32 v[220:221], v[220:221], v[250:251], v[246:247] op_sel_hi:[1,0,0]
    v_mfma_f32_16x16x32_bf16 v[184:187], a[240:243], v[64:67], v[184:187]
    buffer_load_dwordx4 a[128:131], v248, s[36:39], s83 offen offset:0 sc1
    v_pk_fma_f32 v[222:223], v[222:223], v[250:251], v[246:247] op_sel_hi:[1,0,0]
    v_pk_mul_f32 v[216:217], v[216:217], v[160:161]
    v_pk_mul_f32 v[218:219], v[218:219], v[162:163]
    v_pk_mul_f32 v[220:221], v[220:221], v[164:165]
    v_mfma_f32_16x16x32_bf16 v[188:191], a[240:243], v[68:71], v[188:191]
    ds_read_b64_tr_b16 a[236:237], v4 offset:7360
    ds_read_b64_tr_b16 a[238:239], v4 offset:9152
    v_pk_mul_f32 v[222:223], v[222:223], v[166:167]
    v_exp_f32 v216, v216
    buffer_load_dwordx4 a[132:135], v249, s[36:39], s83 offen offset:0 sc1
    v_mfma_f32_16x16x32_bf16 v[192:195], a[244:247], v[64:67], v[192:195]
    v_exp_f32 v217, v217
    v_exp_f32 v218, v218
    v_exp_f32 v219, v219
    v_exp_f32 v220, v220
    v_mfma_f32_16x16x32_bf16 v[196:199], a[244:247], v[68:71], v[196:199]
    s_waitcnt lgkmcnt(8)
    ds_read_b64_tr_b16 a[240:241], v4 offset:14496
    ds_read_b64_tr_b16 a[242:243], v4 offset:16288
    v_exp_f32 v221, v221
    v_exp_f32 v222, v222
    v_mfma_f32_16x16x32_bf16 v[184:187], a[248:251], v[72:75], v[184:187]
    buffer_load_dwordx4 a[136:139], v248, s[36:39], s83 offen offset:2048 sc1
    v_exp_f32 v223, v223
    v_pk_fma_f32 v[216:217], v[216:217], v[244:245], v[244:245] op_sel_hi:[1,0,0]
    v_pk_fma_f32 v[218:219], v[218:219], v[244:245], v[244:245] op_sel_hi:[1,0,0]
    v_pk_fma_f32 v[220:221], v[220:221], v[6:7], v[6:7] op_sel_hi:[1,0,0]
    v_mfma_f32_16x16x32_bf16 v[188:191], a[248:251], v[76:79], v[188:191]
    ds_read_b64_tr_b16 a[244:245], v4 offset:14528
    ds_read_b64_tr_b16 a[246:247], v4 offset:16320
    v_pk_fma_f32 v[222:223], v[222:223], v[6:7], v[6:7] op_sel_hi:[1,0,0]
    v_rcp_f32 v216, v216
    buffer_load_dwordx4 a[140:143], v249, s[36:39], s83 offen offset:2048 sc1
    v_mfma_f32_16x16x32_bf16 v[192:195], a[252:255], v[72:75], v[192:195]
    v_rcp_f32 v217, v217
    v_rcp_f32 v218, v218
    v_rcp_f32 v219, v219
    v_rcp_f32 v220, v220
    v_mfma_f32_16x16x32_bf16 v[196:199], a[252:255], v[76:79], v[196:199]
    s_waitcnt lgkmcnt(8)
    ds_read_b64_tr_b16 a[248:249], v4 offset:21664
    ds_read_b64_tr_b16 a[250:251], v4 offset:23456
    v_rcp_f32 v221, v221
    v_rcp_f32 v222, v222
    s_add_u32 s83, s83, 4096
    v_mfma_f32_16x16x32_bf16 v[184:187], a[224:227], v[80:83], v[184:187]
    v_rcp_f32 v223, v223
    v_pk_mul_f32 v[216:217], v[216:217], v[160:161]
    v_pk_mul_f32 v[218:219], v[218:219], v[162:163]
    v_pk_mul_f32 v[220:221], v[220:221], v[164:165]
    v_pk_mul_f32 v[222:223], v[222:223], v[166:167]
    v_mfma_f32_16x16x32_bf16 v[188:191], a[224:227], v[84:87], v[188:191]
    ds_read_b64_tr_b16 a[252:253], v4 offset:21696
    ds_read_b64_tr_b16 a[254:255], v4 offset:23488
    v_cvt_pk_bf16_f32 v160, v216, v217
    buffer_load_dwordx4 a[144:147], v248, s[36:39], s83 offen offset:0 sc1
    v_cvt_pk_bf16_f32 v161, v218, v219
    v_cvt_pk_bf16_f32 v162, v220, v221
    v_mfma_f32_16x16x32_bf16 v[192:195], a[228:231], v[80:83], v[192:195]
    v_cvt_pk_bf16_f32 v163, v222, v223
    v_permlane16_swap_b32 v160, v162
    v_mfma_f32_16x16x32_bf16 v[196:199], a[228:231], v[84:87], v[196:199]
    s_waitcnt lgkmcnt(8)
    ds_read_b64_tr_b16 a[224:225], v4 offset:28832
    ds_read_b64_tr_b16 a[226:227], v4 offset:30624
    v_permlane16_swap_b32 v161, v163
    buffer_store_dwordx4 v[160:163], v1, s[36:39], s94 offen offset:2048 sc1
    v_pk_mul_f32 v[224:225], v[168:169], v[168:169]
    v_mfma_f32_16x16x32_bf16 v[184:187], a[232:235], v[88:91], v[184:187]
    buffer_load_dwordx4 a[148:151], v249, s[36:39], s83 offen offset:0 sc1
    v_pk_mul_f32 v[226:227], v[170:171], v[170:171]
    v_pk_mul_f32 v[228:229], v[172:173], v[172:173]
    v_pk_mul_f32 v[230:231], v[174:175], v[174:175]
    v_pk_fma_f32 v[224:225], v[224:225], v[242:243], v[240:241] op_sel_hi:[1,0,0]
    v_mfma_f32_16x16x32_bf16 v[188:191], a[232:235], v[92:95], v[188:191]
    ds_read_b64_tr_b16 a[228:229], v4 offset:28864
    ds_read_b64_tr_b16 a[230:231], v4 offset:30656
    v_pk_fma_f32 v[226:227], v[226:227], v[242:243], v[240:241] op_sel_hi:[1,0,0]
    v_pk_fma_f32 v[228:229], v[228:229], v[250:251], v[246:247] op_sel_hi:[1,0,0]
    v_pk_fma_f32 v[230:231], v[230:231], v[250:251], v[246:247] op_sel_hi:[1,0,0]
    buffer_load_dwordx4 a[152:155], v248, s[36:39], s83 offen offset:2048 sc1
    v_mfma_f32_16x16x32_bf16 v[192:195], a[236:239], v[88:91], v[192:195]
    v_pk_mul_f32 v[224:225], v[224:225], v[168:169]
    v_pk_mul_f32 v[226:227], v[226:227], v[170:171]
    v_pk_mul_f32 v[228:229], v[228:229], v[172:173]
    v_pk_mul_f32 v[230:231], v[230:231], v[174:175]
    v_exp_f32 v224, v224
    v_mfma_f32_16x16x32_bf16 v[196:199], a[236:239], v[92:95], v[196:199]
    s_waitcnt lgkmcnt(8)
    ds_read_b64_tr_b16 a[232:233], v4 offset:36000
    ds_read_b64_tr_b16 a[234:235], v4 offset:37792
    v_exp_f32 v225, v225
    v_exp_f32 v226, v226
    v_mfma_f32_16x16x32_bf16 v[184:187], a[240:243], v[96:99], v[184:187]
    buffer_load_dwordx4 a[156:159], v249, s[36:39], s83 offen offset:2048 sc1
    v_exp_f32 v227, v227
    v_exp_f32 v228, v228
    v_exp_f32 v229, v229
    v_mfma_f32_16x16x32_bf16 v[188:191], a[240:243], v[100:103], v[188:191]
    ds_read_b64_tr_b16 a[236:237], v4 offset:36032
    ds_read_b64_tr_b16 a[238:239], v4 offset:37824
    v_exp_f32 v230, v230
    v_exp_f32 v231, v231
    v_pk_fma_f32 v[224:225], v[224:225], v[244:245], v[244:245] op_sel_hi:[1,0,0]
    v_pk_fma_f32 v[226:227], v[226:227], v[244:245], v[244:245] op_sel_hi:[1,0,0]
    v_mfma_f32_16x16x32_bf16 v[192:195], a[244:247], v[96:99], v[192:195]
    s_add_u32 s83, s83, 4096
    v_pk_fma_f32 v[228:229], v[228:229], v[6:7], v[6:7] op_sel_hi:[1,0,0]
    v_pk_fma_f32 v[230:231], v[230:231], v[6:7], v[6:7] op_sel_hi:[1,0,0]
    v_rcp_f32 v224, v224
    v_rcp_f32 v225, v225
    v_mfma_f32_16x16x32_bf16 v[196:199], a[244:247], v[100:103], v[196:199]
    s_waitcnt lgkmcnt(8)
    ds_read_b64_tr_b16 a[240:241], v4 offset:43168
    ds_read_b64_tr_b16 a[242:243], v4 offset:44960
    v_rcp_f32 v226, v226
    v_rcp_f32 v227, v227
    v_rcp_f32 v228, v228
    v_mfma_f32_16x16x32_bf16 v[184:187], a[248:251], v[104:107], v[184:187]
    buffer_load_dwordx4 a[160:163], v248, s[36:39], s83 offen offset:0 sc1
    v_rcp_f32 v229, v229
    v_rcp_f32 v230, v230
    v_rcp_f32 v231, v231
    v_pk_mul_f32 v[224:225], v[224:225], v[168:169]
    v_mfma_f32_16x16x32_bf16 v[188:191], a[248:251], v[108:111], v[188:191]
    ds_read_b64_tr_b16 a[244:245], v4 offset:43200
    ds_read_b64_tr_b16 a[246:247], v4 offset:44992
    v_pk_mul_f32 v[226:227], v[226:227], v[170:171]
    v_pk_mul_f32 v[228:229], v[228:229], v[172:173]
    v_pk_mul_f32 v[230:231], v[230:231], v[174:175]
    buffer_load_dwordx4 a[164:167], v249, s[36:39], s83 offen offset:0 sc1
    v_mfma_f32_16x16x32_bf16 v[192:195], a[252:255], v[104:107], v[192:195]
    v_cvt_pk_bf16_f32 v168, v224, v225
    v_cvt_pk_bf16_f32 v169, v226, v227
    v_cvt_pk_bf16_f32 v170, v228, v229
    v_cvt_pk_bf16_f32 v171, v230, v231
    v_mfma_f32_16x16x32_bf16 v[196:199], a[252:255], v[108:111], v[196:199]
    s_waitcnt lgkmcnt(8)
    ds_read_b64_tr_b16 a[248:249], v4 offset:50336
    ds_read_b64_tr_b16 a[250:251], v4 offset:52128
    v_permlane16_swap_b32 v168, v170
    v_permlane16_swap_b32 v169, v171
    v_mfma_f32_16x16x32_bf16 v[184:187], a[224:227], v[112:115], v[184:187]
    buffer_store_dwordx4 v[168:171], v1, s[36:39], s94 offen offset:3072 sc1
    v_pk_mul_f32 v[216:217], v[176:177], v[176:177]
    buffer_load_dwordx4 a[168:171], v248, s[36:39], s83 offen offset:2048 sc1
    v_pk_mul_f32 v[218:219], v[178:179], v[178:179]
    v_pk_mul_f32 v[220:221], v[180:181], v[180:181]
    v_mfma_f32_16x16x32_bf16 v[188:191], a[224:227], v[116:119], v[188:191]
    ds_read_b64_tr_b16 a[252:253], v4 offset:50368
    ds_read_b64_tr_b16 a[254:255], v4 offset:52160
    v_pk_mul_f32 v[222:223], v[182:183], v[182:183]
    v_pk_fma_f32 v[216:217], v[216:217], v[242:243], v[240:241] op_sel_hi:[1,0,0]
    v_pk_fma_f32 v[218:219], v[218:219], v[242:243], v[240:241] op_sel_hi:[1,0,0]
    v_pk_fma_f32 v[220:221], v[220:221], v[250:251], v[246:247] op_sel_hi:[1,0,0]
    v_mfma_f32_16x16x32_bf16 v[192:195], a[228:231], v[112:115], v[192:195]
    buffer_load_dwordx4 a[172:175], v249, s[36:39], s83 offen offset:2048 sc1
    v_pk_fma_f32 v[222:223], v[222:223], v[250:251], v[246:247] op_sel_hi:[1,0,0]
    v_pk_mul_f32 v[216:217], v[216:217], v[176:177]
    v_pk_mul_f32 v[218:219], v[218:219], v[178:179]
    v_pk_mul_f32 v[220:221], v[220:221], v[180:181]
    v_mfma_f32_16x16x32_bf16 v[196:199], a[228:231], v[116:119], v[196:199]
    s_waitcnt lgkmcnt(8)
    v_pk_mul_f32 v[222:223], v[222:223], v[182:183]
    v_exp_f32 v216, v216
    s_add_u32 s83, s83, 4096
    v_exp_f32 v217, v217
    v_exp_f32 v218, v218
    v_mfma_f32_16x16x32_bf16 v[184:187], a[232:235], v[120:123], v[184:187]
    v_exp_f32 v219, v219
    v_exp_f32 v220, v220
    v_exp_f32 v221, v221
    v_exp_f32 v222, v222
    v_mfma_f32_16x16x32_bf16 v[188:191], a[232:235], v[124:127], v[188:191]
    buffer_load_dwordx4 a[176:179], v248, s[36:39], s83 offen offset:0 sc1
    v_exp_f32 v223, v223
    v_pk_fma_f32 v[216:217], v[216:217], v[244:245], v[244:245] op_sel_hi:[1,0,0]
    v_pk_fma_f32 v[218:219], v[218:219], v[244:245], v[244:245] op_sel_hi:[1,0,0]
    v_pk_fma_f32 v[220:221], v[220:221], v[6:7], v[6:7] op_sel_hi:[1,0,0]
    v_mfma_f32_16x16x32_bf16 v[192:195], a[236:239], v[120:123], v[192:195]
    v_pk_fma_f32 v[222:223], v[222:223], v[6:7], v[6:7] op_sel_hi:[1,0,0]
    v_rcp_f32 v216, v216
    buffer_load_dwordx4 a[180:183], v249, s[36:39], s83 offen offset:0 sc1
    v_rcp_f32 v217, v217
    v_mfma_f32_16x16x32_bf16 v[196:199], a[236:239], v[124:127], v[196:199]
    s_waitcnt lgkmcnt(4)
    v_rcp_f32 v218, v218
    v_rcp_f32 v219, v219
    v_rcp_f32 v220, v220
    v_rcp_f32 v221, v221
    v_mfma_f32_16x16x32_bf16 v[184:187], a[240:243], v[128:131], v[184:187]
    v_rcp_f32 v222, v222
    buffer_load_dwordx4 a[184:187], v248, s[36:39], s83 offen offset:2048 sc1
    v_rcp_f32 v223, v223
    v_pk_mul_f32 v[216:217], v[216:217], v[176:177]
    v_mfma_f32_16x16x32_bf16 v[188:191], a[240:243], v[132:135], v[188:191]
    v_pk_mul_f32 v[218:219], v[218:219], v[178:179]
    v_pk_mul_f32 v[220:221], v[220:221], v[180:181]
    v_pk_mul_f32 v[222:223], v[222:223], v[182:183]
    v_cvt_pk_bf16_f32 v176, v216, v217
    buffer_load_dwordx4 a[188:191], v249, s[36:39], s83 offen offset:2048 sc1
    v_mfma_f32_16x16x32_bf16 v[192:195], a[244:247], v[128:131], v[192:195]
    v_cvt_pk_bf16_f32 v177, v218, v219
    v_cvt_pk_bf16_f32 v178, v220, v221
    v_cvt_pk_bf16_f32 v179, v222, v223
    v_mfma_f32_16x16x32_bf16 v[196:199], a[244:247], v[132:135], v[196:199]
    s_waitcnt lgkmcnt(0)
    v_permlane16_swap_b32 v176, v178
    v_permlane16_swap_b32 v177, v179
    s_add_u32 s94, s94, 4096
    buffer_store_dwordx4 v[176:179], v1, s[36:39], s94 offen offset:0 sc1
    v_mfma_f32_16x16x32_bf16 v[184:187], a[248:251], v[136:139], v[184:187]
    v_mfma_f32_16x16x32_bf16 v[188:191], a[248:251], v[140:143], v[188:191]
    v_mfma_f32_16x16x32_bf16 v[192:195], a[252:255], v[136:139], v[192:195]
    v_mfma_f32_16x16x32_bf16 v[196:199], a[252:255], v[140:143], v[196:199]
    v_mfma_f32_16x16x32_bf16 v[184:187], a[216:219], v[208:211], v[184:187]
    v_mfma_f32_16x16x32_bf16 v[188:191], a[216:219], v[212:215], v[188:191]
    v_mfma_f32_16x16x32_bf16 v[192:195], a[220:223], v[208:211], v[192:195]
    v_mfma_f32_16x16x32_bf16 v[196:199], a[220:223], v[212:215], v[196:199]
    s_or_b32 s95, s2, s5
    s_cmp_eq_u32 s95, 0
    s_cselect_b32 s66, 0, 0x10000000
    s_cselect_b64 s[68:69], -1, 0
    s_mov_b32 s67, 24576
    v_min_u32 v12, 31, v0
    v_lshl_add_u32 v12, v12, 7, s66
    v_mov_b32 v14, s66
    buffer_load_dword v13, v12, s[36:39], s67 offen sc1
    v_pk_mul_f32 v[224:225], v[184:185], v[184:185]
    s_add_u32 s83, s83, 4096
    v_pk_mul_f32 v[226:227], v[186:187], v[186:187]
    v_pk_mul_f32 v[228:229], v[188:189], v[188:189]
    v_pk_mul_f32 v[230:231], v[190:191], v[190:191]
    v_pk_fma_f32 v[224:225], v[224:225], v[242:243], v[240:241] op_sel_hi:[1,0,0]
    v_pk_fma_f32 v[226:227], v[226:227], v[242:243], v[240:241] op_sel_hi:[1,0,0]
    v_pk_fma_f32 v[228:229], v[228:229], v[250:251], v[246:247] op_sel_hi:[1,0,0]
    v_pk_fma_f32 v[230:231], v[230:231], v[250:251], v[246:247] op_sel_hi:[1,0,0]
    v_pk_mul_f32 v[224:225], v[224:225], v[184:185]
    v_pk_mul_f32 v[226:227], v[226:227], v[186:187]
    v_pk_mul_f32 v[228:229], v[228:229], v[188:189]
    v_pk_mul_f32 v[230:231], v[230:231], v[190:191]
    v_exp_f32 v224, v224
    v_exp_f32 v225, v225
    v_exp_f32 v226, v226
    buffer_load_dwordx4 a[192:195], v248, s[36:39], s83 offen offset:0 sc1
    v_exp_f32 v227, v227
    v_exp_f32 v228, v228
    v_exp_f32 v229, v229
    v_exp_f32 v230, v230
    v_exp_f32 v231, v231
    v_pk_fma_f32 v[224:225], v[224:225], v[244:245], v[244:245] op_sel_hi:[1,0,0]
    v_pk_fma_f32 v[226:227], v[226:227], v[244:245], v[244:245] op_sel_hi:[1,0,0]
    v_pk_fma_f32 v[228:229], v[228:229], v[6:7], v[6:7] op_sel_hi:[1,0,0]
    v_pk_fma_f32 v[230:231], v[230:231], v[6:7], v[6:7] op_sel_hi:[1,0,0]
    v_rcp_f32 v224, v224
    v_rcp_f32 v225, v225
    v_rcp_f32 v226, v226
    v_rcp_f32 v227, v227
    v_rcp_f32 v228, v228
    buffer_load_dwordx4 a[196:199], v249, s[36:39], s83 offen offset:0 sc1
    v_rcp_f32 v229, v229
    v_rcp_f32 v230, v230
    v_rcp_f32 v231, v231
    v_pk_mul_f32 v[224:225], v[224:225], v[184:185]
    v_pk_mul_f32 v[226:227], v[226:227], v[186:187]
    v_pk_mul_f32 v[228:229], v[228:229], v[188:189]
    v_pk_mul_f32 v[230:231], v[230:231], v[190:191]
    v_cvt_pk_bf16_f32 v184, v224, v225
    v_cvt_pk_bf16_f32 v185, v226, v227
    v_cvt_pk_bf16_f32 v186, v228, v229
    v_cvt_pk_bf16_f32 v187, v230, v231
    s_nop 0
    v_permlane16_swap_b32 v184, v186
    v_permlane16_swap_b32 v185, v187
    buffer_store_dwordx4 v[184:187], v1, s[36:39], s94 offen offset:1024 sc1
    v_pk_mul_f32 v[216:217], v[192:193], v[192:193]
    buffer_load_dwordx4 a[200:203], v248, s[36:39], s83 offen offset:2048 sc1
    v_pk_mul_f32 v[218:219], v[194:195], v[194:195]
    v_pk_mul_f32 v[220:221], v[196:197], v[196:197]
    v_pk_mul_f32 v[222:223], v[198:199], v[198:199]
    v_pk_fma_f32 v[216:217], v[216:217], v[242:243], v[240:241] op_sel_hi:[1,0,0]
    v_pk_fma_f32 v[218:219], v[218:219], v[242:243], v[240:241] op_sel_hi:[1,0,0]
    v_pk_fma_f32 v[220:221], v[220:221], v[250:251], v[246:247] op_sel_hi:[1,0,0]
    v_pk_fma_f32 v[222:223], v[222:223], v[250:251], v[246:247] op_sel_hi:[1,0,0]
    v_pk_mul_f32 v[216:217], v[216:217], v[192:193]
    v_pk_mul_f32 v[218:219], v[218:219], v[194:195]
    v_pk_mul_f32 v[220:221], v[220:221], v[196:197]
    v_pk_mul_f32 v[222:223], v[222:223], v[198:199]
    v_exp_f32 v216, v216
    v_exp_f32 v217, v217
    v_exp_f32 v218, v218
    v_exp_f32 v219, v219
    v_exp_f32 v220, v220
    v_exp_f32 v221, v221
    v_exp_f32 v222, v222
    v_exp_f32 v223, v223
    v_pk_fma_f32 v[216:217], v[216:217], v[244:245], v[244:245] op_sel_hi:[1,0,0]
    v_pk_fma_f32 v[218:219], v[218:219], v[244:245], v[244:245] op_sel_hi:[1,0,0]
    buffer_load_dwordx4 a[204:207], v249, s[36:39], s83 offen offset:2048 sc1
    v_pk_fma_f32 v[220:221], v[220:221], v[6:7], v[6:7] op_sel_hi:[1,0,0]
    v_pk_fma_f32 v[222:223], v[222:223], v[6:7], v[6:7] op_sel_hi:[1,0,0]
    v_rcp_f32 v216, v216
    v_rcp_f32 v217, v217
    v_rcp_f32 v218, v218
    v_rcp_f32 v219, v219
    v_rcp_f32 v220, v220
    v_rcp_f32 v221, v221
    v_rcp_f32 v222, v222
    v_rcp_f32 v223, v223
    v_pk_mul_f32 v[216:217], v[216:217], v[192:193]
    v_pk_mul_f32 v[218:219], v[218:219], v[194:195]
    v_pk_mul_f32 v[220:221], v[220:221], v[196:197]
    v_pk_mul_f32 v[222:223], v[222:223], v[198:199]
    v_cvt_pk_bf16_f32 v192, v216, v217
    v_cvt_pk_bf16_f32 v193, v218, v219
    v_cvt_pk_bf16_f32 v194, v220, v221
    v_cvt_pk_bf16_f32 v195, v222, v223
    s_nop 0
    v_permlane16_swap_b32 v192, v194
    v_permlane16_swap_b32 v193, v195
    buffer_store_dwordx4 v[192:195], v1, s[36:39], s94 offen offset:2048 sc1
    s_lshl_b32 s94, s90, 1
    s_lshr_b32 s95, s5, 1
    s_add_u32 s94, s94, s95
    s_lshl_b32 s94, s94, 4
    s_add_u32 s94, s94, s91
    s_lshl_b32 s94, s94, 1
    s_and_b32 s95, s5, 1
    s_add_u32 s94, s94, s95
    s_lshl_b32 s94, s94, 2
    s_add_u32 s87, s94, 40960
    s_add_u32 s83, s83, 4096
    buffer_load_dwordx4 a[208:211], v248, s[36:39], s83 offen offset:0 sc1
    buffer_load_dwordx4 a[212:215], v249, s[36:39], s83 offen offset:0 sc1
    buffer_load_dwordx4 a[216:219], v248, s[36:39], s83 offen offset:2048 sc1
    buffer_load_dwordx4 a[220:223], v249, s[36:39], s83 offen offset:2048 sc1
    s_lshl_b32 s94, s89, 7
    s_and_b32 s95, s5, 1
    s_lshl_b32 s95, s95, 6
    s_add_u32 s94, s94, s95
    v_lshrrev_b32 v4, 5, v0
    v_add_u32 v3, 157696, v2
    s_lshr_b32 s96, s5, 1
    s_mul_i32 s97, s96, 4608
    s_add_u32 s97, s97, s95
    s_add_u32 s97, s97, 8192
    v_and_b32 v6, 31, v0
    v_mul_u32_u24 v5, 144, v6
    v_lshl_add_u32 v5, v4, 3, v5
    v_add_u32 v5, s97, v5
    ds_read_b64 v[120:121], v5 offset:0
    ds_read_b64 v[122:123], v5 offset:16
    ds_read_b64 v[124:125], v5 offset:32
    ds_read_b64 v[126:127], v5 offset:48
    ds_read_b64 v[240:241], v3 offset:5120
    ds_read_b64 v[242:243], v3 offset:5136
    ds_read_b64 v[244:245], v3 offset:5152
    ds_read_b64 v[246:247], v3 offset:5168
    s_xor_b32 s97, s5, 1
    s_mul_i32 s97, s97, 12288
    s_add_u32 s97, s97, 0
    v_add_u32 v81, s97, v1
    s_xor_b32 s97, s5, 2
    s_mul_i32 s97, s97, 12288
    s_add_u32 s97, s97, 4096
    v_add_u32 v82, s97, v1
    s_xor_b32 s97, s5, 3
    s_mul_i32 s97, s97, 12288
    s_add_u32 s97, s97, 8192
    v_add_u32 v83, s97, v1
    s_mul_i32 s97, s5, 12288
    v_add_u32 v88, s97, v1
    v_and_b32 v7, 15, v0
    v_lshlrev_b32 v7, 11, v7
    v_lshrrev_b32 v6, 4, v6
    v_lshl_add_u32 v7, v6, 10, v7
    v_lshl_add_u32 v7, v4, 4, v7
    s_lshl_b32 s96, s96, 15
    s_lshl_b32 s97, s88, 16
    s_add_u32 s96, s96, s97
    s_add_u32 s86, s96, s94
    v_lshlrev_b32 v96, 16, v232
    v_and_b32 v97, s0, v232
    v_lshlrev_b32 v98, 16, v233
    v_and_b32 v99, s0, v233
    v_lshlrev_b32 v100, 16, v234
    v_and_b32 v101, s0, v234
    v_lshlrev_b32 v102, 16, v235
    v_and_b32 v103, s0, v235
    v_lshlrev_b32 v104, 16, v236
    v_and_b32 v105, s0, v236
    v_lshlrev_b32 v106, 16, v237
    v_and_b32 v107, s0, v237
    v_lshlrev_b32 v108, 16, v238
    v_and_b32 v109, s0, v238
    v_lshlrev_b32 v110, 16, v239
    v_and_b32 v111, s0, v239
    s_waitcnt lgkmcnt(7)
    v_lshlrev_b32 v192, 16, v120
    v_and_b32 v193, s0, v120
    v_lshlrev_b32 v194, 16, v121
    v_and_b32 v195, s0, v121
    s_waitcnt lgkmcnt(6)
    v_lshlrev_b32 v196, 16, v122
    v_and_b32 v197, s0, v122
    v_lshlrev_b32 v198, 16, v123
    v_and_b32 v199, s0, v123
    s_waitcnt lgkmcnt(5)
    v_lshlrev_b32 v200, 16, v124
    v_and_b32 v201, s0, v124
    v_lshlrev_b32 v202, 16, v125
    v_and_b32 v203, s0, v125
    s_waitcnt lgkmcnt(4)
    v_lshlrev_b32 v204, 16, v126
    v_and_b32 v205, s0, v126
    v_lshlrev_b32 v206, 16, v127
    v_and_b32 v207, s0, v127
    s_waitcnt lgkmcnt(3)
    v_lshlrev_b32 v208, 16, v240
    v_and_b32 v209, s0, v240
    v_lshlrev_b32 v210, 16, v241
    v_and_b32 v211, s0, v241
    s_waitcnt lgkmcnt(2)
    v_lshlrev_b32 v212, 16, v242
    v_and_b32 v213, s0, v242
    v_lshlrev_b32 v214, 16, v243
    v_and_b32 v215, s0, v243
    s_waitcnt lgkmcnt(1)
    v_lshlrev_b32 v216, 16, v244
    v_and_b32 v217, s0, v244
    v_lshlrev_b32 v218, 16, v245
    v_and_b32 v219, s0, v245
    s_waitcnt lgkmcnt(0)
    v_lshlrev_b32 v220, 16, v246
    v_and_b32 v221, s0, v246
    v_lshlrev_b32 v222, 16, v247
    v_and_b32 v223, s0, v247
    s_mov_b64 exec, 1
    s_waitcnt vmcnt(4)
    buffer_store_dword v252, off, s[36:39], s87
    s_sub_u32 s87, s87, 12288
    s_mov_b64 exec, -1
    s_mov_b64 exec, s[68:69]
    v_cmp_ne_u32 vcc, s6, v13
    s_nop 0
    s_cbranch_vccnz L_spin7
L_back7:
    s_mov_b64 exec, 1
    buffer_store_dword v252, v14, s[36:39], 0 offen sc1
    s_mov_b64 exec, -1
    s_lshl_b32 s94, s88, 7
    s_lshl_b32 s95, s5, 5
    s_add_u32 s94, s94, s95
    s_add_u32 s94, s94, 40960
    s_mov_b32 s84, s94
    v_and_b32 v4, 1, v0
    v_bfe_u32 v3, v0, 1, 1
    v_mad_u32_u24 v4, v3, 6, v4
    v_lshlrev_b32 v4, 2, v4
    v_and_b32 v3, 3, v0
    v_lshl_add_u32 v3, v3, 2, 8
    s_mul_i32 s96, s88, 229376
    s_mul_i32 s95, s5, 28672
    s_add_u32 s96, s96, s95
    s_add_u32 s96, s96, 5242880
    s_lshr_b32 s95, s5, 1
    s_mul_i32 s95, s95, 114688
    s_add_u32 s97, s96, 114688
    s_sub_u32 s97, s97, s95
    s_add_u32 s96, s96, s95
    buffer_load_dword v5, v4, s[36:39], s94 offen sc1
    s_waitcnt vmcnt(0)
    v_cmp_ne_u32 vcc, s6, v5
    s_nop 0
    s_cbranch_vccnz L_spin4
L_back4:
    buffer_load_dwordx4 v[16:19], v1, s[36:39], s96 offen offset:0 sc1
    buffer_load_dwordx4 v[20:23], v1, s[36:39], s97 offen offset:0 sc1
    buffer_load_dwordx4 v[24:27], v1, s[36:39], s96 offen offset:1024 sc1
    buffer_load_dwordx4 v[28:31], v1, s[36:39], s97 offen offset:1024 sc1
    buffer_load_dwordx4 v[32:35], v1, s[36:39], s96 offen offset:2048 sc1
    buffer_load_dwordx4 v[36:39], v1, s[36:39], s97 offen offset:2048 sc1
    buffer_load_dwordx4 v[40:43], v1, s[36:39], s96 offen offset:3072 sc1
    buffer_load_dwordx4 v[44:47], v1, s[36:39], s97 offen offset:3072 sc1
    s_add_u32 s96, s96, 4096
    s_add_u32 s97, s97, 4096
    buffer_load_dwordx4 v[48:51], v1, s[36:39], s96 offen offset:0 sc1
    buffer_load_dwordx4 v[52:55], v1, s[36:39], s97 offen offset:0 sc1
    buffer_load_dwordx4 v[56:59], v1, s[36:39], s96 offen offset:1024 sc1
    buffer_load_dwordx4 v[60:63], v1, s[36:39], s97 offen offset:1024 sc1
    s_mov_b64 exec, 1
    buffer_store_dword v252, off, s[36:39], s87 sc1
    s_mov_b64 exec, -1
    s_barrier
    s_waitcnt vmcnt(12)
    v_mfma_f32_32x32x16_bf16 v[128:143], a[0:3], v[16:19], 0
    buffer_load_dwordx4 v[64:67], v1, s[36:39], s96 offen offset:2048 sc1
    v_mfma_f32_32x32x16_bf16 v[144:159], a[4:7], v[16:19], 0
    buffer_load_dwordx4 v[68:71], v1, s[36:39], s97 offen offset:2048 sc1
    s_waitcnt vmcnt(13)
    v_mfma_f32_32x32x16_bf16 v[160:175], a[0:3], v[20:23], 0
    v_mfma_f32_32x32x16_bf16 v[176:191], a[4:7], v[20:23], 0
    s_waitcnt vmcnt(12)
    v_mfma_f32_32x32x16_bf16 v[128:143], a[8:11], v[24:27], v[128:143]
    s_add_u32 s96, s96, 17408
    s_add_u32 s97, s97, 17408
    v_mfma_f32_32x32x16_bf16 v[144:159], a[12:15], v[24:27], v[144:159]
    buffer_load_dwordx4 v[72:75], v1, s[36:39], s96 offen offset:0 sc1
    s_waitcnt vmcnt(12)
    v_mfma_f32_32x32x16_bf16 v[160:175], a[8:11], v[28:31], v[160:175]
    buffer_load_dwordx4 v[76:79], v1, s[36:39], s97 offen offset:0 sc1
    v_mfma_f32_32x32x16_bf16 v[176:191], a[12:15], v[28:31], v[176:191]
    s_waitcnt vmcnt(12)
    v_mfma_f32_32x32x16_bf16 v[128:143], a[16:19], v[32:35], v[128:143]
    buffer_load_dwordx4 v[16:19], v1, s[36:39], s96 offen offset:1024 sc1
    v_mfma_f32_32x32x16_bf16 v[144:159], a[20:23], v[32:35], v[144:159]
    buffer_load_dwordx4 v[20:23], v1, s[36:39], s97 offen offset:1024 sc1
    s_waitcnt vmcnt(13)
    v_mfma_f32_32x32x16_bf16 v[160:175], a[16:19], v[36:39], v[160:175]
    buffer_load_dword v6, v3, s[36:39], s84 offen sc1
    v_mfma_f32_32x32x16_bf16 v[176:191], a[20:23], v[36:39], v[176:191]
    s_waitcnt vmcnt(13)
    v_mfma_f32_32x32x16_bf16 v[128:143], a[24:27], v[40:43], v[128:143]
    buffer_load_dwordx4 v[24:27], v1, s[36:39], s96 offen offset:2048 sc1
    v_mfma_f32_32x32x16_bf16 v[144:159], a[28:31], v[40:43], v[144:159]
    buffer_load_dwordx4 v[28:31], v1, s[36:39], s97 offen offset:2048 sc1
    s_waitcnt vmcnt(14)
    v_mfma_f32_32x32x16_bf16 v[160:175], a[24:27], v[44:47], v[160:175]
    v_mfma_f32_32x32x16_bf16 v[176:191], a[28:31], v[44:47], v[176:191]
    s_waitcnt vmcnt(13)
    v_mfma_f32_32x32x16_bf16 v[128:143], a[32:35], v[48:51], v[128:143]
    buffer_load_dwordx4 v[32:35], v1, s[36:39], s96 offen offset:3072 sc1
    v_mfma_f32_32x32x16_bf16 v[144:159], a[36:39], v[48:51], v[144:159]
    buffer_load_dwordx4 v[36:39], v1, s[36:39], s97 offen offset:3072 sc1
    s_waitcnt vmcnt(14)
    v_mfma_f32_32x32x16_bf16 v[160:175], a[32:35], v[52:55], v[160:175]
    v_mfma_f32_32x32x16_bf16 v[176:191], a[36:39], v[52:55], v[176:191]
    s_waitcnt vmcnt(13)
    v_mfma_f32_32x32x16_bf16 v[128:143], a[40:43], v[56:59], v[128:143]
    s_add_u32 s96, s96, 4096
    s_add_u32 s97, s97, 4096
    v_mfma_f32_32x32x16_bf16 v[144:159], a[44:47], v[56:59], v[144:159]
    buffer_load_dwordx4 v[40:43], v1, s[36:39], s96 offen offset:0 sc1
    s_waitcnt vmcnt(13)
    v_mfma_f32_32x32x16_bf16 v[160:175], a[40:43], v[60:63], v[160:175]
    buffer_load_dwordx4 v[44:47], v1, s[36:39], s97 offen offset:0 sc1
    v_mfma_f32_32x32x16_bf16 v[176:191], a[44:47], v[60:63], v[176:191]
    s_waitcnt vmcnt(12)
    v_mfma_f32_32x32x16_bf16 v[128:143], a[48:51], v[64:67], v[128:143]
    buffer_load_dwordx4 v[48:51], v1, s[36:39], s96 offen offset:1024 sc1
    v_mfma_f32_32x32x16_bf16 v[144:159], a[52:55], v[64:67], v[144:159]
    buffer_load_dwordx4 v[52:55], v1, s[36:39], s97 offen offset:1024 sc1
    s_waitcnt vmcnt(13)
    v_mfma_f32_32x32x16_bf16 v[160:175], a[48:51], v[68:71], v[160:175]
    v_mfma_f32_32x32x16_bf16 v[176:191], a[52:55], v[68:71], v[176:191]
    s_waitcnt vmcnt(12)
    v_mfma_f32_32x32x16_bf16 v[128:143], a[168:171], v[72:75], v[128:143]
    buffer_load_dwordx4 v[56:59], v1, s[36:39], s96 offen offset:2048 sc1
    v_mfma_f32_32x32x16_bf16 v[144:159], a[172:175], v[72:75], v[144:159]
    buffer_load_dwordx4 v[60:63], v1, s[36:39], s97 offen offset:2048 sc1
    s_waitcnt vmcnt(13)
    v_mfma_f32_32x32x16_bf16 v[160:175], a[168:171], v[76:79], v[160:175]
    v_mfma_f32_32x32x16_bf16 v[176:191], a[172:175], v[76:79], v[176:191]
    s_waitcnt vmcnt(10)
    v_cmp_ne_u32 vcc, s6, v6
    s_nop 0
    s_cbranch_vccnz L_spin8
L_back8:
    v_mfma_f32_32x32x16_bf16 v[128:143], a[176:179], v[16:19], v[128:143]
    s_sub_u32 s96, s96, 18432
    s_sub_u32 s97, s97, 18432
    v_mfma_f32_32x32x16_bf16 v[144:159], a[180:183], v[16:19], v[144:159]
    buffer_load_dwordx4 v[64:67], v1, s[36:39], s96 offen offset:0 sc1
    v_mfma_f32_32x32x16_bf16 v[160:175], a[176:179], v[20:23], v[160:175]
    buffer_load_dwordx4 v[68:71], v1, s[36:39], s97 offen offset:0 sc1
    v_mfma_f32_32x32x16_bf16 v[176:191], a[180:183], v[20:23], v[176:191]
    s_waitcnt vmcnt(11)
    v_mfma_f32_32x32x16_bf16 v[128:143], a[184:187], v[24:27], v[128:143]
    buffer_load_dwordx4 v[72:75], v1, s[36:39], s96 offen offset:1024 sc1
    v_mfma_f32_32x32x16_bf16 v[144:159], a[188:191], v[24:27], v[144:159]
    buffer_load_dwordx4 v[76:79], v1, s[36:39], s97 offen offset:1024 sc1
    s_waitcnt vmcnt(12)
    v_mfma_f32_32x32x16_bf16 v[160:175], a[184:187], v[28:31], v[160:175]
    v_mfma_f32_32x32x16_bf16 v[176:191], a[188:191], v[28:31], v[176:191]
    s_waitcnt vmcnt(11)
    v_mfma_f32_32x32x16_bf16 v[128:143], a[192:195], v[32:35], v[128:143]
    buffer_load_dwordx4 v[16:19], v1, s[36:39], s96 offen offset:2048 sc1
    v_mfma_f32_32x32x16_bf16 v[144:159], a[196:199], v[32:35], v[144:159]
    buffer_load_dwordx4 v[20:23], v1, s[36:39], s97 offen offset:2048 sc1
    s_waitcnt vmcnt(12)
    v_mfma_f32_32x32x16_bf16 v[160:175], a[192:195], v[36:39], v[160:175]
    v_mfma_f32_32x32x16_bf16 v[176:191], a[196:199], v[36:39], v[176:191]
    s_waitcnt vmcnt(11)
    v_mfma_f32_32x32x16_bf16 v[128:143], a[200:203], v[40:43], v[128:143]
    buffer_load_dwordx4 v[24:27], v1, s[36:39], s96 offen offset:3072 sc1
    v_mfma_f32_32x32x16_bf16 v[144:159], a[204:207], v[40:43], v[144:159]
    buffer_load_dwordx4 v[28:31], v1, s[36:39], s97 offen offset:3072 sc1
    s_waitcnt vmcnt(12)
    v_mfma_f32_32x32x16_bf16 v[160:175], a[200:203], v[44:47], v[160:175]
    v_mfma_f32_32x32x16_bf16 v[176:191], a[204:207], v[44:47], v[176:191]
    s_waitcnt vmcnt(11)
    v_mfma_f32_32x32x16_bf16 v[128:143], a[208:211], v[48:51], v[128:143]
    s_add_u32 s96, s96, 4096
    s_add_u32 s97, s97, 4096
    v_mfma_f32_32x32x16_bf16 v[144:159], a[212:215], v[48:51], v[144:159]
    buffer_load_dwordx4 v[32:35], v1, s[36:39], s96 offen offset:0 sc1
    s_waitcnt vmcnt(11)
    v_mfma_f32_32x32x16_bf16 v[160:175], a[208:211], v[52:55], v[160:175]
    buffer_load_dwordx4 v[36:39], v1, s[36:39], s97 offen offset:0 sc1
    v_mfma_f32_32x32x16_bf16 v[176:191], a[212:215], v[52:55], v[176:191]
    s_waitcnt vmcnt(11)
    v_mfma_f32_32x32x16_bf16 v[128:143], a[216:219], v[56:59], v[128:143]
    buffer_load_dwordx4 v[40:43], v1, s[36:39], s96 offen offset:1024 sc1
    v_mfma_f32_32x32x16_bf16 v[144:159], a[220:223], v[56:59], v[144:159]
    buffer_load_dwordx4 v[44:47], v1, s[36:39], s97 offen offset:1024 sc1
    s_waitcnt vmcnt(12)
    v_mfma_f32_32x32x16_bf16 v[160:175], a[216:219], v[60:63], v[160:175]
    v_mfma_f32_32x32x16_bf16 v[176:191], a[220:223], v[60:63], v[176:191]
    s_waitcnt vmcnt(11)
    v_mfma_f32_32x32x16_bf16 v[128:143], a[56:59], v[64:67], v[128:143]
    buffer_load_dwordx4 v[48:51], v1, s[36:39], s96 offen offset:2048 sc1
    v_mfma_f32_32x32x16_bf16 v[144:159], a[60:63], v[64:67], v[144:159]
    buffer_load_dwordx4 v[52:55], v1, s[36:39], s97 offen offset:2048 sc1
    s_waitcnt vmcnt(12)
    v_mfma_f32_32x32x16_bf16 v[160:175], a[56:59], v[68:71], v[160:175]
    v_mfma_f32_32x32x16_bf16 v[176:191], a[60:63], v[68:71], v[176:191]
    s_waitcnt vmcnt(11)
    v_mfma_f32_32x32x16_bf16 v[128:143], a[64:67], v[72:75], v[128:143]
    buffer_load_dwordx4 v[56:59], v1, s[36:39], s96 offen offset:3072 sc1
    v_mfma_f32_32x32x16_bf16 v[144:159], a[68:71], v[72:75], v[144:159]
    buffer_load_dwordx4 v[60:63], v1, s[36:39], s97 offen offset:3072 sc1
    s_waitcnt vmcnt(12)
    v_mfma_f32_32x32x16_bf16 v[160:175], a[64:67], v[76:79], v[160:175]
    v_mfma_f32_32x32x16_bf16 v[176:191], a[68:71], v[76:79], v[176:191]
    s_waitcnt vmcnt(11)
    v_mfma_f32_32x32x16_bf16 v[128:143], a[72:75], v[16:19], v[128:143]
    s_add_u32 s96, s96, 4096
    s_add_u32 s97, s97, 4096
    v_mfma_f32_32x32x16_bf16 v[144:159], a[76:79], v[16:19], v[144:159]
    buffer_load_dwordx4 v[64:67], v1, s[36:39], s96 offen offset:0 sc1
    s_waitcnt vmcnt(11)
    v_mfma_f32_32x32x16_bf16 v[160:175], a[72:75], v[20:23], v[160:175]
    buffer_load_dwordx4 v[68:71], v1, s[36:39], s97 offen offset:0 sc1
    v_mfma_f32_32x32x16_bf16 v[176:191], a[76:79], v[20:23], v[176:191]
    s_waitcnt vmcnt(11)
    v_mfma_f32_32x32x16_bf16 v[128:143], a[80:83], v[24:27], v[128:143]
    buffer_load_dwordx4 v[72:75], v1, s[36:39], s96 offen offset:1024 sc1
    v_mfma_f32_32x32x16_bf16 v[144:159], a[84:87], v[24:27], v[144:159]
    buffer_load_dwordx4 v[76:79], v1, s[36:39], s97 offen offset:1024 sc1
    s_waitcnt vmcnt(12)
    v_mfma_f32_32x32x16_bf16 v[160:175], a[80:83], v[28:31], v[160:175]
    v_mfma_f32_32x32x16_bf16 v[176:191], a[84:87], v[28:31], v[176:191]
    s_waitcnt vmcnt(11)
    v_mfma_f32_32x32x16_bf16 v[128:143], a[88:91], v[32:35], v[128:143]
    buffer_load_dwordx4 v[16:19], v1, s[36:39], s96 offen offset:2048 sc1
    v_mfma_f32_32x32x16_bf16 v[144:159], a[92:95], v[32:35], v[144:159]
    buffer_load_dwordx4 v[20:23], v1, s[36:39], s97 offen offset:2048 sc1
    s_waitcnt vmcnt(12)
    v_mfma_f32_32x32x16_bf16 v[160:175], a[88:91], v[36:39], v[160:175]
    v_mfma_f32_32x32x16_bf16 v[176:191], a[92:95], v[36:39], v[176:191]
    s_waitcnt vmcnt(11)
    v_mfma_f32_32x32x16_bf16 v[128:143], a[96:99], v[40:43], v[128:143]
    buffer_load_dwordx4 v[24:27], v1, s[36:39], s96 offen offset:3072 sc1
    v_mfma_f32_32x32x16_bf16 v[144:159], a[100:103], v[40:43], v[144:159]
    buffer_load_dwordx4 v[28:31], v1, s[36:39], s97 offen offset:3072 sc1
    s_waitcnt vmcnt(12)
    v_mfma_f32_32x32x16_bf16 v[160:175], a[96:99], v[44:47], v[160:175]
    v_mfma_f32_32x32x16_bf16 v[176:191], a[100:103], v[44:47], v[176:191]
    s_waitcnt vmcnt(11)
    v_mfma_f32_32x32x16_bf16 v[128:143], a[104:107], v[48:51], v[128:143]
    s_add_u32 s96, s96, 4096
    s_add_u32 s97, s97, 4096
    v_mfma_f32_32x32x16_bf16 v[144:159], a[108:111], v[48:51], v[144:159]
    buffer_load_dwordx4 v[32:35], v1, s[36:39], s96 offen offset:0 sc1
    s_waitcnt vmcnt(11)
    v_mfma_f32_32x32x16_bf16 v[160:175], a[104:107], v[52:55], v[160:175]
    buffer_load_dwordx4 v[36:39], v1, s[36:39], s97 offen offset:0 sc1
    v_mfma_f32_32x32x16_bf16 v[176:191], a[108:111], v[52:55], v[176:191]
    s_waitcnt vmcnt(11)
    v_mfma_f32_32x32x16_bf16 v[128:143], a[112:115], v[56:59], v[128:143]
    buffer_load_dwordx4 v[40:43], v1, s[36:39], s96 offen offset:1024 sc1
    v_mfma_f32_32x32x16_bf16 v[144:159], a[116:119], v[56:59], v[144:159]
    buffer_load_dwordx4 v[44:47], v1, s[36:39], s97 offen offset:1024 sc1
    s_waitcnt vmcnt(12)
    v_mfma_f32_32x32x16_bf16 v[160:175], a[112:115], v[60:63], v[160:175]
    v_mfma_f32_32x32x16_bf16 v[176:191], a[116:119], v[60:63], v[176:191]
    s_waitcnt vmcnt(11)
    v_mfma_f32_32x32x16_bf16 v[128:143], a[120:123], v[64:67], v[128:143]
    v_mfma_f32_32x32x16_bf16 v[144:159], a[124:127], v[64:67], v[144:159]
    s_waitcnt vmcnt(10)
    v_mfma_f32_32x32x16_bf16 v[160:175], a[120:123], v[68:71], v[160:175]
    v_mfma_f32_32x32x16_bf16 v[176:191], a[124:127], v[68:71], v[176:191]
    s_waitcnt vmcnt(9)
    v_mfma_f32_32x32x16_bf16 v[128:143], a[128:131], v[72:75], v[128:143]
    v_mfma_f32_32x32x16_bf16 v[144:159], a[132:135], v[72:75], v[144:159]
    s_waitcnt vmcnt(8)
    v_mfma_f32_32x32x16_bf16 v[160:175], a[128:131], v[76:79], v[160:175]
    v_mfma_f32_32x32x16_bf16 v[176:191], a[132:135], v[76:79], v[176:191]
    s_waitcnt vmcnt(7)
    v_mfma_f32_32x32x16_bf16 v[128:143], a[136:139], v[16:19], v[128:143]
    v_mfma_f32_32x32x16_bf16 v[144:159], a[140:143], v[16:19], v[144:159]
    s_waitcnt vmcnt(6)
    v_mfma_f32_32x32x16_bf16 v[160:175], a[136:139], v[20:23], v[160:175]
    v_mfma_f32_32x32x16_bf16 v[176:191], a[140:143], v[20:23], v[176:191]
    s_waitcnt vmcnt(5)
    v_mfma_f32_32x32x16_bf16 v[128:143], a[144:147], v[24:27], v[128:143]
    v_mfma_f32_32x32x16_bf16 v[144:159], a[148:151], v[24:27], v[144:159]
    s_waitcnt vmcnt(4)
    v_mfma_f32_32x32x16_bf16 v[160:175], a[144:147], v[28:31], v[160:175]
    v_mfma_f32_32x32x16_bf16 v[176:191], a[148:151], v[28:31], v[176:191]
    s_waitcnt vmcnt(3)
    v_mfma_f32_32x32x16_bf16 v[128:143], a[152:155], v[32:35], v[128:143]
    v_mfma_f32_32x32x16_bf16 v[144:159], a[156:159], v[32:35], v[144:159]
    s_waitcnt vmcnt(2)
    v_mfma_f32_32x32x16_bf16 v[160:175], a[152:155], v[36:39], v[160:175]
    v_mfma_f32_32x32x16_bf16 v[176:191], a[156:159], v[36:39], v[176:191]
    s_waitcnt vmcnt(1)
    v_mfma_f32_32x32x16_bf16 v[144:159], a[164:167], v[40:43], v[144:159]
    s_waitcnt vmcnt(0)
    v_mfma_f32_32x32x16_bf16 v[160:175], a[160:163], v[44:47], v[160:175]
    v_mfma_f32_32x32x16_bf16 v[176:191], a[164:167], v[44:47], v[176:191]
    v_mfma_f32_32x32x16_bf16 v[128:143], a[160:163], v[40:43], v[128:143]
    s_nop 7
    ds_write_b128 v81, v[144:147] offset:0
    ds_write_b128 v81, v[148:151] offset:1024
    ds_write_b128 v81, v[152:155] offset:2048
    ds_write_b128 v81, v[156:159] offset:3072
    ds_write_b128 v82, v[160:163] offset:0
    ds_write_b128 v82, v[164:167] offset:1024
    ds_write_b128 v82, v[168:171] offset:2048
    ds_write_b128 v82, v[172:175] offset:3072
    ds_write_b128 v83, v[176:179] offset:0
    ds_write_b128 v83, v[180:183] offset:1024
    ds_write_b128 v83, v[184:187] offset:2048
    ds_write_b128 v83, v[188:191] offset:3072
    v_pk_add_f32 v[96:97], v[96:97], v[128:129]
    v_pk_add_f32 v[98:99], v[98:99], v[130:131]
    v_pk_add_f32 v[100:101], v[100:101], v[132:133]
    v_pk_add_f32 v[102:103], v[102:103], v[134:135]
    v_pk_add_f32 v[104:105], v[104:105], v[136:137]
    v_pk_add_f32 v[106:107], v[106:107], v[138:139]
    v_pk_add_f32 v[108:109], v[108:109], v[140:141]
    v_pk_add_f32 v[110:111], v[110:111], v[142:143]
    s_waitcnt lgkmcnt(0)
    s_barrier
    ds_read_b128 v[16:19], v88 offset:0
    ds_read_b128 v[20:23], v88 offset:1024
    ds_read_b128 v[32:35], v88 offset:4096
    ds_read_b128 v[36:39], v88 offset:5120
    ds_read_b128 v[48:51], v88 offset:8192
    ds_read_b128 v[52:55], v88 offset:9216
    ds_read_b128 v[24:27], v88 offset:2048
    ds_read_b128 v[28:31], v88 offset:3072
    ds_read_b128 v[40:43], v88 offset:6144
    ds_read_b128 v[44:47], v88 offset:7168
    ds_read_b128 v[56:59], v88 offset:10240
    ds_read_b128 v[60:63], v88 offset:11264
    s_waitcnt lgkmcnt(11)
    v_pk_add_f32 v[96:97], v[96:97], v[16:17]
    v_pk_add_f32 v[98:99], v[98:99], v[18:19]
    s_waitcnt lgkmcnt(10)
    v_pk_add_f32 v[100:101], v[100:101], v[20:21]
    v_pk_add_f32 v[102:103], v[102:103], v[22:23]
    s_waitcnt lgkmcnt(9)
    v_pk_add_f32 v[96:97], v[96:97], v[32:33]
    v_pk_add_f32 v[98:99], v[98:99], v[34:35]
    s_waitcnt lgkmcnt(8)
    v_pk_add_f32 v[100:101], v[100:101], v[36:37]
    v_pk_add_f32 v[102:103], v[102:103], v[38:39]
    s_waitcnt lgkmcnt(7)
    v_pk_add_f32 v[96:97], v[96:97], v[48:49]
    v_pk_add_f32 v[98:99], v[98:99], v[50:51]
    s_waitcnt lgkmcnt(6)
    v_pk_add_f32 v[100:101], v[100:101], v[52:53]
    v_pk_add_f32 v[102:103], v[102:103], v[54:55]
    v_pk_fma_f32 v[192:193], v[96:97], v[208:209], v[192:193]
    v_pk_fma_f32 v[194:195], v[98:99], v[210:211], v[194:195]
    v_pk_fma_f32 v[196:197], v[100:101], v[212:213], v[196:197]
    v_pk_fma_f32 v[198:199], v[102:103], v[214:215], v[198:199]
    v_cvt_pk_bf16_f32 v112, v192, v193
    v_cvt_pk_bf16_f32 v113, v194, v195
    v_cvt_pk_bf16_f32 v114, v196, v197
    v_cvt_pk_bf16_f32 v115, v198, v199
    s_nop 0
    v_permlane32_swap_b32 v112, v114
    v_permlane32_swap_b32 v113, v115
    buffer_store_dwordx4 v[112:115], v7, s[32:35], s86 offen offset:0
    s_waitcnt lgkmcnt(5)
    v_pk_add_f32 v[104:105], v[104:105], v[24:25]
    v_pk_add_f32 v[106:107], v[106:107], v[26:27]
    s_waitcnt lgkmcnt(4)
    v_pk_add_f32 v[108:109], v[108:109], v[28:29]
    v_pk_add_f32 v[110:111], v[110:111], v[30:31]
    s_waitcnt lgkmcnt(3)
    v_pk_add_f32 v[104:105], v[104:105], v[40:41]
    v_pk_add_f32 v[106:107], v[106:107], v[42:43]
    s_waitcnt lgkmcnt(2)
    v_pk_add_f32 v[108:109], v[108:109], v[44:45]
    v_pk_add_f32 v[110:111], v[110:111], v[46:47]
    s_waitcnt lgkmcnt(1)
    v_pk_add_f32 v[104:105], v[104:105], v[56:57]
    v_pk_add_f32 v[106:107], v[106:107], v[58:59]
    s_waitcnt lgkmcnt(0)
    v_pk_add_f32 v[108:109], v[108:109], v[60:61]
    v_pk_add_f32 v[110:111], v[110:111], v[62:63]
    v_pk_fma_f32 v[200:201], v[104:105], v[216:217], v[200:201]
    v_pk_fma_f32 v[202:203], v[106:107], v[218:219], v[202:203]
    v_pk_fma_f32 v[204:205], v[108:109], v[220:221], v[204:205]
    v_pk_fma_f32 v[206:207], v[110:111], v[222:223], v[206:207]
    v_cvt_pk_bf16_f32 v116, v200, v201
    v_cvt_pk_bf16_f32 v117, v202, v203
    v_cvt_pk_bf16_f32 v118, v204, v205
    v_cvt_pk_bf16_f32 v119, v206, v207
    s_nop 0
    v_permlane32_swap_b32 v116, v118
    v_permlane32_swap_b32 v117, v119
    buffer_store_dwordx4 v[116:119], v7, s[32:35], s86 offen offset:32
    s_endpgm

L_spin1:
    s_mov_b32 s100, 200000
L_spinl1:
    buffer_load_dwordx4 v[176:179], v2, s[36:39], s85 offen sc1
    buffer_load_dwordx4 v[180:183], v2, s[36:39], s86 offen sc1
    buffer_load_dwordx4 v[184:187], v2, s[36:39], s87 offen sc1
    buffer_load_dwordx4 v[188:191], v2, s[36:39], s93 offen sc1
    s_sub_u32 s100, s100, 1
    s_cbranch_scc1 L_fail1
    s_waitcnt vmcnt(0)
    v_perm_b32 v192, v177, v176, s40
    v_perm_b32 v193, v179, v178, s40
    v_perm_b32 v194, v181, v180, s40
    v_perm_b32 v195, v183, v182, s40
    v_perm_b32 v196, v185, v184, s40
    v_perm_b32 v197, v187, v186, s40
    v_perm_b32 v198, v189, v188, s40
    v_perm_b32 v199, v191, v190, s40
    v_lshl_or_b32 v192, v193, 16, v192
    v_lshl_or_b32 v194, v195, 16, v194
    v_lshl_or_b32 v196, v197, 16, v196
    v_lshl_or_b32 v198, v199, 16, v198
    v_min3_u32 v193, v192, v194, v196
    v_max3_u32 v195, v192, v194, v196
    v_min_u32 v193, v193, v198
    v_max_u32 v195, v195, v198
    v_cmp_ne_u32 vcc, s6, v193
    v_cmp_ne_u32 s[98:99], s6, v195
    s_nop 0
    s_or_b64 vcc, vcc, s[98:99]
    s_nop 4
    s_cbranch_vccnz L_spinl1
    s_branch L_back1
L_fail1:
    v_mov_b32 v10, 1
    s_branch L_fail
L_spin5:
    s_mov_b32 s100, 200000
L_spinl5:
    buffer_load_dwordx4 v[176:179], v12, s[36:39], s82 offen sc1
    buffer_load_dwordx4 v[180:183], v12, s[36:39], s83 offen sc1
    buffer_load_dwordx4 v[184:187], v12, s[36:39], s84 offen sc1
    buffer_load_dwordx4 v[188:191], v12, s[36:39], s85 offen sc1
    buffer_load_dwordx4 v[192:195], v13, s[36:39], s82 offen sc1
    buffer_load_dwordx4 v[196:199], v13, s[36:39], s83 offen sc1
    buffer_load_dwordx4 v[200:203], v13, s[36:39], s84 offen sc1
    buffer_load_dwordx4 v[204:207], v13, s[36:39], s85 offen sc1
    s_sub_u32 s100, s100, 1
    s_cbranch_scc1 L_fail5
    s_waitcnt vmcnt(0)
    v_perm_b32 v48, v177, v176, s40
    v_perm_b32 v49, v179, v178, s40
    v_perm_b32 v50, v181, v180, s40
    v_perm_b32 v51, v183, v182, s40
    v_perm_b32 v52, v185, v184, s40
    v_perm_b32 v53, v187, v186, s40
    v_perm_b32 v54, v189, v188, s40
    v_perm_b32 v55, v191, v190, s40
    v_lshl_or_b32 v48, v49, 16, v48
    v_lshl_or_b32 v50, v51, 16, v50
    v_lshl_or_b32 v52, v53, 16, v52
    v_lshl_or_b32 v54, v55, 16, v54
    v_min3_u32 v49, v48, v50, v52
    v_max3_u32 v51, v48, v50, v52
    v_min_u32 v49, v49, v54
    v_max_u32 v51, v51, v54
    v_perm_b32 v56, v193, v192, s40
    v_perm_b32 v57, v195, v194, s40
    v_perm_b32 v58, v197, v196, s40
    v_perm_b32 v59, v199, v198, s40
    v_perm_b32 v60, v201, v200, s40
    v_perm_b32 v61, v203, v202, s40
    v_perm_b32 v62, v205, v204, s40
    v_perm_b32 v63, v207, v206, s40
    v_lshl_or_b32 v56, v57, 16, v56
    v_lshl_or_b32 v58, v59, 16, v58
    v_lshl_or_b32 v60, v61, 16, v60
    v_lshl_or_b32 v62, v63, 16, v62
    v_min3_u32 v57, v56, v58, v60
    v_max3_u32 v59, v56, v58, v60
    v_min_u32 v57, v57, v62
    v_max_u32 v59, v59, v62
    v_cmp_ne_u32 vcc, s6, v49
    v_cmp_ne_u32 s[98:99], s6, v51
    s_nop 0
    s_or_b64 vcc, vcc, s[98:99]
    v_cmp_ne_u32 s[98:99], s6, v57
    s_nop 0
    s_or_b64 vcc, vcc, s[98:99]
    v_cmp_ne_u32 s[98:99], s6, v59
    s_nop 0
    s_or_b64 vcc, vcc, s[98:99]
    s_nop 4
    s_cbranch_vccnz L_spinl5
    s_branch L_back5
L_fail5:
    v_mov_b32 v10, 5
    s_branch L_fail
L_spin2:
    s_mov_b32 s100, 24
L_spina2:
    buffer_load_dword v10, v9, s[36:39], s56 offen sc1
    s_waitcnt vmcnt(0)
    v_cmp_ne_u32 vcc, s6, v10
    s_nop 4
    s_cbranch_vccz L_back2
    s_sub_u32 s100, s100, 1
    s_cbranch_scc0 L_spina2
    s_sub_u32 s56, s56, 12288
    s_mov_b32 s100, 200000
L_spinl2:
    buffer_load_dword v10, v9, s[36:39], s56 offen sc1
    s_sub_u32 s100, s100, 1
    s_cbranch_scc1 L_fail2
    s_waitcnt vmcnt(0)
    v_cmp_ne_u32 vcc, s6, v10
    s_nop 4
    s_cbranch_vccnz L_spinl2
    s_branch L_back2
L_fail2:
    v_mov_b32 v10, 2
    s_branch L_fail
L_spin6:
    s_mov_b32 s100, 200000
L_spinl6:
    buffer_load_dword v13, v12, s[36:39], s57 offen sc1
    s_sub_u32 s100, s100, 1
    s_cbranch_scc1 L_fail6
    s_waitcnt vmcnt(0)
    v_cmp_ne_u32 vcc, s6, v13
    s_nop 4
    s_cbranch_vccnz L_spinl6
    s_branch L_back6
L_fail6:
    v_mov_b32 v10, 6
    s_branch L_fail
L_spin3:
    s_mov_b32 s100, 24
L_spina3:
    buffer_load_dword v10, v9, s[36:39], s94 offen sc1
    s_waitcnt vmcnt(0)
    v_cmp_ne_u32 vcc, s6, v10
    s_nop 4
    s_cbranch_vccz L_back3
    s_sub_u32 s100, s100, 1
    s_cbranch_scc0 L_spina3
    s_sub_u32 s94, s94, 12288
    s_mov_b32 s100, 200000
L_spinl3:
    buffer_load_dword v10, v9, s[36:39], s94 offen sc1
    s_sub_u32 s100, s100, 1
    s_cbranch_scc1 L_fail3
    s_waitcnt vmcnt(0)
    v_cmp_ne_u32 vcc, s6, v10
    s_nop 4
    s_cbranch_vccnz L_spinl3
    s_branch L_back3
L_fail3:
    v_mov_b32 v10, 3
    s_branch L_fail
L_spin7:
    s_mov_b32 s100, 200000
L_spinl7:
    buffer_load_dword v13, v12, s[36:39], s67 offen sc1
    s_sub_u32 s100, s100, 1
    s_cbranch_scc1 L_fail7
    s_waitcnt vmcnt(0)
    v_cmp_ne_u32 vcc, s6, v13
    s_nop 4
    s_cbranch_vccnz L_spinl7
    s_branch L_back7
L_fail7:
    v_mov_b32 v10, 7
    s_branch L_fail
L_spin4:
    s_mov_b32 s100, 24
L_spina4:
    buffer_load_dword v5, v4, s[36:39], s94 offen sc1
    s_waitcnt vmcnt(0)
    v_cmp_ne_u32 vcc, s6, v5
    s_nop 4
    s_cbranch_vccz L_back4
    s_sub_u32 s100, s100, 1
    s_cbranch_scc0 L_spina4
    s_sub_u32 s94, s94, 12288
    s_mov_b64 exec, 1
    buffer_store_dword v252, off, s[36:39], s87 sc1
    s_mov_b64 exec, -1
    s_mov_b32 s100, 200000
L_spinl4:
    buffer_load_dword v5, v4, s[36:39], s94 offen sc1
    s_sub_u32 s100, s100, 1
    s_cbranch_scc1 L_fail4
    s_waitcnt vmcnt(0)
    v_cmp_ne_u32 vcc, s6, v5
    s_nop 4
    s_cbranch_vccnz L_spinl4
    s_branch L_back4
L_fail4:
    v_mov_b32 v10, 4
    s_branch L_fail
L_spin8:
    s_mov_b32 s100, 24
L_spina8:
    buffer_load_dword v6, v3, s[36:39], s84 offen sc1
    s_waitcnt vmcnt(0)
    v_cmp_ne_u32 vcc, s6, v6
    s_nop 4
    s_cbranch_vccz L_back8
    s_sub_u32 s100, s100, 1
    s_cbranch_scc0 L_spina8
    s_sub_u32 s84, s84, 12288
    s_mov_b32 s100, 200000
L_spinl8:
    buffer_load_dword v6, v3, s[36:39], s84 offen sc1
    s_sub_u32 s100, s100, 1
    s_cbranch_scc1 L_fail8
    s_waitcnt vmcnt(0)
    v_cmp_ne_u32 vcc, s6, v6
    s_nop 4
    s_cbranch_vccnz L_spinl8
    s_branch L_back8
L_fail8:
    v_mov_b32 v10, 8
    s_branch L_fail
L_fail:
    s_mov_b64 exec, 1
    v_lshlrev_b32 v11, 2, v10
    v_mov_b32 v12, s2
    v_add_u32 v12, 1, v12
    global_store_dword v11, v12, s[46:47]
    s_waitcnt vmcnt(0)
L_end:
    s_endpgm
.section .rodata,"a"
.p2align 6
.amdhsa_kernel adaLN_cond__sliding_local_dilated__mixer_channel_mlp__prompt_kernel
  .amdhsa_next_free_vgpr 512
  .amdhsa_next_free_sgpr 102
  .amdhsa_accum_offset 256
  .amdhsa_group_segment_fixed_size 0
  .amdhsa_kernarg_size 104
  .amdhsa_user_sgpr_count 2
  .amdhsa_user_sgpr_kernarg_segment_ptr 1
  .amdhsa_system_sgpr_workgroup_id_x 1
.end_amdhsa_kernel
```
